```python
import torch

def _softmax(x, axis=-1):
    return torch.softmax(x, dim=axis)
def _gelu(x):
    return torch.nn.functional.gelu(x, approximate="tanh")
def _silu(x):
    return torch.nn.functional.silu(x)
def _sigmoid(x):
    return torch.sigmoid(x)
def _layernorm(x, axis=-1, eps=1e-5):
    m = x.mean(dim=axis, keepdim=True)
    v = x.var(dim=axis, keepdim=True, unbiased=False)
    return (x - m) / torch.sqrt(v + eps)
def _scatter_add(tgt, idx, src, axis=0):
    return tgt.clone().index_add_(axis, idx, src)
def _segment_sum(src, seg, n):
    out = torch.zeros((n,) + src.shape[1:], dtype=src.dtype)
    return out.index_add_(0, seg, src)
def _pad(x, pw):
    flat = tuple(v for pair in reversed(pw) for v in pair)
    return torch.nn.functional.pad(x, flat)

kernel_name = 'parallel_sum__sliding_block__dense_activation_silu__prompt'

def setup_inputs():

    _w = (lambda a: (lambda t: t.to(torch.bfloat16) if t.is_floating_point() else t)(torch.as_tensor(a)))
    def _A_setup():
        B, S, D = 1, 2048, 512
        return {
            "x": _w((lambda *s: torch.randn(*s, dtype=torch.bfloat16) * 0.05)(B, S, D)),
            "wqkv": _w((lambda *s: torch.randn(*s, dtype=torch.bfloat16) * 0.05)(D, 3 * D)),
            "wo": _w((lambda *s: torch.randn(*s, dtype=torch.bfloat16) * 0.05)(D, D)),
        }
    _A_in = _A_setup()

    def _B_setup():
        B, S, D, F = 1, 2048, 512, 1376
        return {
            "x": _w((lambda *s: torch.randn(*s, dtype=torch.bfloat16) * 0.05)(B, S, D)),
            "w1": _w((lambda *s: torch.randn(*s, dtype=torch.bfloat16) * 0.8)(D, F) * (D ** -0.5)),
            "w2": _w((lambda *s: torch.randn(*s, dtype=torch.bfloat16) * 0.8)(F, D) * (F ** -0.5)),
        }
    _B_in = _B_setup()

    return {
        "A_x": _A_in["x"],
        "A_wqkv": _A_in["wqkv"],
        "A_wo": _A_in["wo"],
        "B_x": _B_in["x"],
        "B_w1": _B_in["w1"],
        "B_w2": _B_in["w2"],
    }

def reference(A_x, A_wqkv, A_wo, B_x, B_w1, B_w2):
    def _A_ref(x, wqkv, wo):
        B, S, D = x.shape
        H = 32; Dh = D // H; W = 256
        qkv = (lambda x, *d: x.permute(*d))((x @ wqkv).reshape(B, S, 3, H, Dh), 2, 0, 3, 1, 4)
        q, k, v = qkv[0], qkv[1], qkv[2]
        scores = torch.einsum("bhqd,bhkd->bhqk", q, k) * (Dh ** -0.5)
        idx = torch.arange(S)
        mask = (idx[:, None] - idx[None, :] >= 0) & (idx[:, None] - idx[None, :] < W)
        scores = torch.where(mask[None, None], scores, -1e9)
        p = _softmax(scores, axis=-1)
        o = torch.einsum("bhqk,bhkd->bhqd", p, v)
        return (lambda x, *d: x.permute(*d))(o, 0, 2, 1, 3).reshape(B, S, D) @ wo

    def _B_ref(x, w1, w2):
        h = torch.einsum("bsd,df->bsf", x, w1)
        h = _silu(h)
        out = torch.einsum("bsf,fd->bsd", h, w2)
        return out

    x = A_x
    xn = _layernorm(x, axis=-1)
    return x + _A_ref(xn, A_wqkv, A_wo) + _B_ref(xn, B_w1, B_w2)
```

```asm
; @launch grid=(256,1,1) block=(512,1,1) lds=163840
.amdgcn_target "amdgcn-amd-amdhsa--gfx950"
.text
.globl parallel_sum__sliding_block__dense_activation_silu__prompt_kernel
.p2align 8
.type parallel_sum__sliding_block__dense_activation_silu__prompt_kernel,@function
parallel_sum__sliding_block__dense_activation_silu__prompt_kernel:
  s_cmp_ge_u32 s2, 256
  s_cbranch_scc1 L_end
  s_load_dwordx16 s[64:79], s[0:1], 0
  s_load_dwordx2 s[80:81], s[0:1], 64
  v_lshrrev_b32 v3, 6, v0
  v_and_b32 v1, 63, v0
  v_readfirstlane_b32 s42, v3
  s_and_b32 s47, s2, 7
  s_lshr_b32 s48, s2, 3
  s_getpc_b64 s[4:5]
L_pc:
  v_lshl_add_u32 v4, s48, 3, v3
  v_min_u32 v4, (L_end-L_pc)>>7, v4
  v_lshlrev_b32 v4, 7, v4
  v_mov_b32 v5, s5
  v_add_co_u32 v4, vcc, s4, v4
  v_addc_co_u32 v5, vcc, 0, v5, vcc
  global_load_dword v2, v[4:5], off
  s_nop 1
  s_lshr_b32 s40, s48, 3
  s_lshr_b32 s49, s47, 1
  s_lshl_b32 s49, s49, 2
  s_add_u32 s40, s40, s49
  s_and_b32 s41, s48, 7
  s_and_b32 s49, s47, 1
  s_lshl_b32 s49, s49, 3
  s_add_u32 s41, s41, s49
  s_lshr_b32 s51, s48, 3
  s_lshl_b32 s49, s47, 2
  s_add_u32 s51, s51, s49
  s_and_b32 s52, s48, 7
  s_lshl_b32 s55, s40, 4
  s_add_u32 s55, s55, s41
  s_and_b32 s43, s42, 3
  s_lshr_b32 s44, s42, 2
  s_and_b32 s54, s42, 1
  s_lshr_b32 s53, s42, 1
  s_lshl_b32 s46, s40, 2
  s_add_u32 s46, s46, s43
  s_mov_b32 s45, 0x3f803f80
  s_lshl_b32 s59, s40, 1
  s_add_u32 s59, s59, s41
  s_and_b32 s59, s59, 7
  v_lshrrev_b32 v3, 3, v1
  v_and_b32 v10, 7, v1
  v_lshlrev_b32 v4, 4, v10
  v_lshl_add_u32 v4, v3, 10, v4
  v_add_u32 v5, 8192, v4
  s_lshl_b32 s47, s40, 17
  s_lshl_b32 s48, s42, 14
  s_add_u32 s47, s47, s48
  s_waitcnt lgkmcnt(0)
  s_mov_b32 s8, s64
  s_mov_b32 s9, s65
  s_mov_b32 s10, 2097152
  s_mov_b32 s11, 0x20000
  s_mov_b32 s57, s47
  s_mov_b32 s58, s59
  s_add_u32 s3, s58, 0
  s_and_b32 s3, s3, 7
  s_lshl_b32 s3, s3, 7
  s_add_u32 s3, s3, s57
  buffer_load_dwordx4 v[192:195], v4, s[8:11], s3 offen
  buffer_load_dwordx4 v[196:199], v5, s[8:11], s3 offen
  s_add_u32 s3, s58, 1
  s_and_b32 s3, s3, 7
  s_lshl_b32 s3, s3, 7
  s_add_u32 s3, s3, s57
  buffer_load_dwordx4 v[200:203], v4, s[8:11], s3 offen
  buffer_load_dwordx4 v[204:207], v5, s[8:11], s3 offen
  s_add_u32 s4, s80, 14680064
  s_addc_u32 s5, s81, 0
  s_load_dwordx2 s[6:7], s[4:5], 0
  s_mov_b32 s12, s66
  s_mov_b32 s13, s67
  s_mov_b32 s14, 1572864
  s_mov_b32 s15, 0x20000
  s_mov_b32 s16, s68
  s_mov_b32 s17, s69
  s_mov_b32 s18, 524288
  s_mov_b32 s19, 0x20000
  s_mov_b32 s20, s72
  s_mov_b32 s21, s73
  s_mov_b32 s22, 1409024
  s_mov_b32 s23, 0x20000
  s_mov_b32 s24, s74
  s_mov_b32 s25, s75
  s_mov_b32 s26, 1409024
  s_mov_b32 s27, 0x20000
  s_mov_b32 s28, s76
  s_mov_b32 s29, s77
  s_mov_b32 s30, 2097152
  s_mov_b32 s31, 0x20000
  s_mov_b32 s32, s78
  s_mov_b32 s33, s79
  s_mov_b32 s34, 256
  s_mov_b32 s35, 0x20000
  s_mov_b32 s36, s80
  s_mov_b32 s37, s81
  s_mov_b32 s38, 16777216
  s_mov_b32 s39, 0x20000
  v_xor_b32 v10, v10, v3
  v_lshlrev_b32 v10, 4, v10
  v_lshl_add_u32 v6, v3, 9, v10
  s_lshl_b32 s48, s42, 13
  s_add_u32 s48, s48, 98304
  v_add_u32 v6, s48, v6
  v_lshrrev_b32 v3, 2, v1
  v_lshrrev_b32 v10, 5, v1
  v_lshlrev_b32 v10, 1, v10
  v_xor_b32 v10, v10, v1
  v_and_b32 v10, 3, v10
  v_lshlrev_b32 v10, 4, v10
  v_mul_u32_u24 v8, 3072, v3
  v_add_u32 v8, v8, v10
  v_mul_u32_u24 v9, 2752, v3
  v_add_u32 v9, v9, v10
  v_lshlrev_b32 v14, 4, v1
  s_mul_i32 s56, s42, 3072
  s_lshl_b32 s99, s41, 6
  s_add_u32 s99, s99, 2048
  s_and_b32 s98, s41, 1
  s_lshl_b32 s98, s98, 10
  s_lshr_b32 s47, s41, 1
  s_lshl_b32 s47, s47, 7
  s_add_u32 s98, s98, s47
  s_mul_i32 s100, s41, 3
  s_min_u32 s100, s100, 40
  s_lshl_b32 s100, s100, 6
  s_add_u32 s59, s59, s44
  v_and_b32 v3, 15, v1
  v_lshrrev_b32 v10, 4, v1
  v_xor_b32 v11, v10, v3
  v_lshlrev_b32 v11, 4, v11
  v_lshl_add_u32 v11, v3, 9, v11
  s_lshl_b32 s48, s43, 14
  s_add_u32 s48, s48, 98304
  v_add_u32 v7, s48, v11
  v_lshrrev_b32 v11, 5, v1
  v_lshl_add_u32 v15, v11, 4, v3
  v_and_b32 v12, 1, v10
  v_lshl_add_u32 v15, v12, 5, v15
  v_lshlrev_b32 v15, 4, v15
  v_mul_u32_u24 v11, 3072, v11
  v_lshl_add_u32 v11, v12, 9, v11
  v_xor_b32 v12, s44, v12
  v_lshl_add_u32 v11, v12, 5, v11
  v_bfe_u32 v3, v1, 2, 2
  v_lshl_add_u32 v11, v3, 6, v11
  v_and_b32 v3, 3, v1
  v_lshl_add_u32 v11, v3, 3, v11
  v_add_u32 v12, 49152, v11
  v_add_u32 v13, 98304, v11
  v_lshrrev_b32 v3, 4, v1
  v_bfe_u32 v10, v1, 2, 2
  v_cmp_eq_u32 vcc, v3, v10
  v_mov_b32 v3, s45
  s_nop 0
  v_cndmask_b32 v176, 0, v3, vcc
  v_cndmask_b32 v177, 0, v3, vcc
  v_cndmask_b32 v178, 0, v3, vcc
  v_cndmask_b32 v179, 0, v3, vcc
  s_mov_b32 s82, 0xaaaaaaaa
  s_mov_b32 s83, s82
  s_mov_b32 s84, 0xcccccccc
  s_mov_b32 s85, s84
  s_waitcnt vmcnt(3)
  s_add_u32 s3, s58, 2
  s_and_b32 s3, s3, 7
  s_lshl_b32 s3, s3, 7
  s_add_u32 s3, s3, s57
  buffer_load_dwordx4 v[208:211], v4, s[8:11], s3 offen
  v_mfma_f32_16x16x32_bf16 v[152:155], v[176:179], v[192:195], 0
  v_mfma_f32_4x4x4_16b_bf16 v[160:163], v[192:193], v[192:193], 0
  v_lshlrev_b32 v16, 16, v192
  v_and_b32 v17, 0xffff0000, v192
  v_lshlrev_b32 v18, 16, v193
  v_and_b32 v19, 0xffff0000, v193
  v_mfma_f32_4x4x4_16b_bf16 v[164:167], v[194:195], v[194:195], 0
  v_lshlrev_b32 v20, 16, v194
  v_and_b32 v21, 0xffff0000, v194
  v_lshlrev_b32 v22, 16, v195
  v_and_b32 v23, 0xffff0000, v195
  s_waitcnt vmcnt(3)
  buffer_load_dwordx4 v[212:215], v5, s[8:11], s3 offen
  v_mfma_f32_16x16x32_bf16 v[156:159], v[176:179], v[196:199], 0
  v_mfma_f32_4x4x4_16b_bf16 v[168:171], v[196:197], v[196:197], 0
  v_lshlrev_b32 v24, 16, v196
  v_and_b32 v25, 0xffff0000, v196
  v_lshlrev_b32 v26, 16, v197
  v_and_b32 v27, 0xffff0000, v197
  v_mfma_f32_4x4x4_16b_bf16 v[172:175], v[198:199], v[198:199], 0
  v_lshlrev_b32 v28, 16, v198
  v_and_b32 v29, 0xffff0000, v198
  v_lshlrev_b32 v30, 16, v199
  v_and_b32 v31, 0xffff0000, v199
  s_waitcnt vmcnt(3)
  s_add_u32 s3, s58, 3
  s_and_b32 s3, s3, 7
  s_lshl_b32 s3, s3, 7
  s_add_u32 s3, s3, s57
  buffer_load_dwordx4 v[216:219], v4, s[8:11], s3 offen
  v_mfma_f32_16x16x32_bf16 v[152:155], v[176:179], v[200:203], v[152:155]
  v_mfma_f32_4x4x4_16b_bf16 v[160:163], v[200:201], v[200:201], v[160:163]
  v_lshlrev_b32 v32, 16, v200
  v_and_b32 v33, 0xffff0000, v200
  v_lshlrev_b32 v34, 16, v201
  v_and_b32 v35, 0xffff0000, v201
  v_mfma_f32_4x4x4_16b_bf16 v[164:167], v[202:203], v[202:203], v[164:167]
  v_lshlrev_b32 v36, 16, v202
  v_and_b32 v37, 0xffff0000, v202
  v_lshlrev_b32 v38, 16, v203
  v_and_b32 v39, 0xffff0000, v203
  s_waitcnt vmcnt(3)
  buffer_load_dwordx4 v[220:223], v5, s[8:11], s3 offen
  v_mfma_f32_16x16x32_bf16 v[156:159], v[176:179], v[204:207], v[156:159]
  v_mfma_f32_4x4x4_16b_bf16 v[168:171], v[204:205], v[204:205], v[168:171]
  v_lshlrev_b32 v40, 16, v204
  v_and_b32 v41, 0xffff0000, v204
  v_lshlrev_b32 v42, 16, v205
  v_and_b32 v43, 0xffff0000, v205
  v_mfma_f32_4x4x4_16b_bf16 v[172:175], v[206:207], v[206:207], v[172:175]
  v_lshlrev_b32 v44, 16, v206
  v_and_b32 v45, 0xffff0000, v206
  v_lshlrev_b32 v46, 16, v207
  v_and_b32 v47, 0xffff0000, v207
  s_waitcnt vmcnt(3)
  s_add_u32 s3, s58, 4
  s_and_b32 s3, s3, 7
  s_lshl_b32 s3, s3, 7
  s_add_u32 s3, s3, s57
  buffer_load_dwordx4 v[224:227], v4, s[8:11], s3 offen
  v_mfma_f32_16x16x32_bf16 v[152:155], v[176:179], v[208:211], v[152:155]
  v_mfma_f32_4x4x4_16b_bf16 v[160:163], v[208:209], v[208:209], v[160:163]
  v_lshlrev_b32 v48, 16, v208
  v_and_b32 v49, 0xffff0000, v208
  v_lshlrev_b32 v50, 16, v209
  v_and_b32 v51, 0xffff0000, v209
  v_mfma_f32_4x4x4_16b_bf16 v[164:167], v[210:211], v[210:211], v[164:167]
  v_lshlrev_b32 v52, 16, v210
  v_and_b32 v53, 0xffff0000, v210
  v_lshlrev_b32 v54, 16, v211
  v_and_b32 v55, 0xffff0000, v211
  s_waitcnt vmcnt(3)
  buffer_load_dwordx4 v[228:231], v5, s[8:11], s3 offen
  v_mfma_f32_16x16x32_bf16 v[156:159], v[176:179], v[212:215], v[156:159]
  v_mfma_f32_4x4x4_16b_bf16 v[168:171], v[212:213], v[212:213], v[168:171]
  v_lshlrev_b32 v56, 16, v212
  v_and_b32 v57, 0xffff0000, v212
  v_lshlrev_b32 v58, 16, v213
  v_and_b32 v59, 0xffff0000, v213
  v_mfma_f32_4x4x4_16b_bf16 v[172:175], v[214:215], v[214:215], v[172:175]
  v_lshlrev_b32 v60, 16, v214
  v_and_b32 v61, 0xffff0000, v214
  v_lshlrev_b32 v62, 16, v215
  v_and_b32 v63, 0xffff0000, v215
  s_waitcnt vmcnt(3)
  s_add_u32 s3, s58, 5
  s_and_b32 s3, s3, 7
  s_lshl_b32 s3, s3, 7
  s_add_u32 s3, s3, s57
  buffer_load_dwordx4 v[232:235], v4, s[8:11], s3 offen
  v_mfma_f32_16x16x32_bf16 v[152:155], v[176:179], v[216:219], v[152:155]
  v_mfma_f32_4x4x4_16b_bf16 v[160:163], v[216:217], v[216:217], v[160:163]
  v_lshlrev_b32 v64, 16, v216
  v_and_b32 v65, 0xffff0000, v216
  v_lshlrev_b32 v66, 16, v217
  v_and_b32 v67, 0xffff0000, v217
  v_mfma_f32_4x4x4_16b_bf16 v[164:167], v[218:219], v[218:219], v[164:167]
  v_lshlrev_b32 v68, 16, v218
  v_and_b32 v69, 0xffff0000, v218
  v_lshlrev_b32 v70, 16, v219
  v_and_b32 v71, 0xffff0000, v219
  s_waitcnt vmcnt(3)
  buffer_load_dwordx4 v[236:239], v5, s[8:11], s3 offen
  v_mfma_f32_16x16x32_bf16 v[156:159], v[176:179], v[220:223], v[156:159]
  v_mfma_f32_4x4x4_16b_bf16 v[168:171], v[220:221], v[220:221], v[168:171]
  v_lshlrev_b32 v72, 16, v220
  v_and_b32 v73, 0xffff0000, v220
  v_lshlrev_b32 v74, 16, v221
  v_and_b32 v75, 0xffff0000, v221
  v_mfma_f32_4x4x4_16b_bf16 v[172:175], v[222:223], v[222:223], v[172:175]
  v_lshlrev_b32 v76, 16, v222
  v_and_b32 v77, 0xffff0000, v222
  v_lshlrev_b32 v78, 16, v223
  v_and_b32 v79, 0xffff0000, v223
  s_waitcnt vmcnt(3)
  s_add_u32 s3, s58, 6
  s_and_b32 s3, s3, 7
  s_lshl_b32 s3, s3, 7
  s_add_u32 s3, s3, s57
  buffer_load_dwordx4 v[240:243], v4, s[8:11], s3 offen
  v_mfma_f32_16x16x32_bf16 v[152:155], v[176:179], v[224:227], v[152:155]
  v_mfma_f32_4x4x4_16b_bf16 v[160:163], v[224:225], v[224:225], v[160:163]
  v_lshlrev_b32 v80, 16, v224
  v_and_b32 v81, 0xffff0000, v224
  v_lshlrev_b32 v82, 16, v225
  v_and_b32 v83, 0xffff0000, v225
  v_mfma_f32_4x4x4_16b_bf16 v[164:167], v[226:227], v[226:227], v[164:167]
  v_lshlrev_b32 v84, 16, v226
  v_and_b32 v85, 0xffff0000, v226
  v_lshlrev_b32 v86, 16, v227
  v_and_b32 v87, 0xffff0000, v227
  s_waitcnt vmcnt(3)
  buffer_load_dwordx4 v[244:247], v5, s[8:11], s3 offen
  v_mfma_f32_16x16x32_bf16 v[156:159], v[176:179], v[228:231], v[156:159]
  v_mfma_f32_4x4x4_16b_bf16 v[168:171], v[228:229], v[228:229], v[168:171]
  v_lshlrev_b32 v88, 16, v228
  v_and_b32 v89, 0xffff0000, v228
  v_lshlrev_b32 v90, 16, v229
  v_and_b32 v91, 0xffff0000, v229
  v_mfma_f32_4x4x4_16b_bf16 v[172:175], v[230:231], v[230:231], v[172:175]
  v_lshlrev_b32 v92, 16, v230
  v_and_b32 v93, 0xffff0000, v230
  v_lshlrev_b32 v94, 16, v231
  v_and_b32 v95, 0xffff0000, v231
  s_waitcnt vmcnt(3)
  s_add_u32 s3, s58, 7
  s_and_b32 s3, s3, 7
  s_lshl_b32 s3, s3, 7
  s_add_u32 s3, s3, s57
  buffer_load_dwordx4 v[248:251], v4, s[8:11], s3 offen
  v_mfma_f32_16x16x32_bf16 v[152:155], v[176:179], v[232:235], v[152:155]
  v_mfma_f32_4x4x4_16b_bf16 v[160:163], v[232:233], v[232:233], v[160:163]
  v_lshlrev_b32 v96, 16, v232
  v_and_b32 v97, 0xffff0000, v232
  v_lshlrev_b32 v98, 16, v233
  v_and_b32 v99, 0xffff0000, v233
  v_mfma_f32_4x4x4_16b_bf16 v[164:167], v[234:235], v[234:235], v[164:167]
  v_lshlrev_b32 v100, 16, v234
  v_and_b32 v101, 0xffff0000, v234
  v_lshlrev_b32 v102, 16, v235
  v_and_b32 v103, 0xffff0000, v235
  s_waitcnt vmcnt(3)
  buffer_load_dwordx4 v[252:255], v5, s[8:11], s3 offen
  v_mfma_f32_16x16x32_bf16 v[156:159], v[176:179], v[236:239], v[156:159]
  v_mfma_f32_4x4x4_16b_bf16 v[168:171], v[236:237], v[236:237], v[168:171]
  v_lshlrev_b32 v104, 16, v236
  v_and_b32 v105, 0xffff0000, v236
  v_lshlrev_b32 v106, 16, v237
  v_and_b32 v107, 0xffff0000, v237
  v_mfma_f32_4x4x4_16b_bf16 v[172:175], v[238:239], v[238:239], v[172:175]
  v_lshlrev_b32 v108, 16, v238
  v_and_b32 v109, 0xffff0000, v238
  v_lshlrev_b32 v110, 16, v239
  v_and_b32 v111, 0xffff0000, v239
  s_waitcnt vmcnt(3)
  s_add_u32 s49, s59, 0
  s_and_b32 s49, s49, 7
  s_lshl_b32 s49, s49, 2
  s_add_u32 s49, s49, s43
  s_mul_i32 s49, s49, 49152
  s_add_u32 s50, s49, s99
  s_add_u32 s49, s49, s98
  s_add_u32 m0, s56, 0
  s_nop 0
  buffer_load_dwordx4 v8, s[12:15], s49 offen offset:0 lds
  v_mfma_f32_16x16x32_bf16 v[152:155], v[176:179], v[240:243], v[152:155]
  v_mfma_f32_4x4x4_16b_bf16 v[160:163], v[240:241], v[240:241], v[160:163]
  v_lshlrev_b32 v112, 16, v240
  v_and_b32 v113, 0xffff0000, v240
  v_lshlrev_b32 v114, 16, v241
  v_and_b32 v115, 0xffff0000, v241
  v_mfma_f32_4x4x4_16b_bf16 v[164:167], v[242:243], v[242:243], v[164:167]
  v_lshlrev_b32 v116, 16, v242
  v_and_b32 v117, 0xffff0000, v242
  v_lshlrev_b32 v118, 16, v243
  v_and_b32 v119, 0xffff0000, v243
  s_waitcnt vmcnt(3)
  s_add_u32 m0, s56, 960
  s_nop 0
  buffer_load_dwordx4 v8, s[12:15], s49 offen offset:64 lds
  v_mfma_f32_16x16x32_bf16 v[156:159], v[176:179], v[244:247], v[156:159]
  v_mfma_f32_4x4x4_16b_bf16 v[168:171], v[244:245], v[244:245], v[168:171]
  v_lshlrev_b32 v120, 16, v244
  v_and_b32 v121, 0xffff0000, v244
  v_lshlrev_b32 v122, 16, v245
  v_and_b32 v123, 0xffff0000, v245
  v_mfma_f32_4x4x4_16b_bf16 v[172:175], v[246:247], v[246:247], v[172:175]
  v_lshlrev_b32 v124, 16, v246
  v_and_b32 v125, 0xffff0000, v246
  v_lshlrev_b32 v126, 16, v247
  v_and_b32 v127, 0xffff0000, v247
  s_waitcnt vmcnt(3)
  s_add_u32 m0, s56, 2048
  s_nop 0
  buffer_load_dwordx4 v8, s[12:15], s50 offen lds
  v_mfma_f32_16x16x32_bf16 v[152:155], v[176:179], v[248:251], v[152:155]
  v_mfma_f32_4x4x4_16b_bf16 v[160:163], v[248:249], v[248:249], v[160:163]
  v_lshlrev_b32 v128, 16, v248
  v_and_b32 v129, 0xffff0000, v248
  v_lshlrev_b32 v130, 16, v249
  v_and_b32 v131, 0xffff0000, v249
  v_mfma_f32_4x4x4_16b_bf16 v[164:167], v[250:251], v[250:251], v[164:167]
  v_lshlrev_b32 v132, 16, v250
  v_and_b32 v133, 0xffff0000, v250
  v_lshlrev_b32 v134, 16, v251
  v_and_b32 v135, 0xffff0000, v251
  s_waitcnt vmcnt(3)
  s_add_u32 s49, s59, 2
  s_and_b32 s49, s49, 7
  s_lshl_b32 s49, s49, 2
  s_add_u32 s49, s49, s43
  s_mul_i32 s49, s49, 49152
  s_add_u32 s50, s49, s99
  s_add_u32 s49, s49, s98
  s_add_u32 m0, s56, 24576
  s_nop 0
  buffer_load_dwordx4 v8, s[12:15], s49 offen offset:0 lds
  v_mfma_f32_16x16x32_bf16 v[156:159], v[176:179], v[252:255], v[156:159]
  v_mfma_f32_4x4x4_16b_bf16 v[168:171], v[252:253], v[252:253], v[168:171]
  v_lshlrev_b32 v136, 16, v252
  v_and_b32 v137, 0xffff0000, v252
  v_lshlrev_b32 v138, 16, v253
  v_and_b32 v139, 0xffff0000, v253
  v_mfma_f32_4x4x4_16b_bf16 v[172:175], v[254:255], v[254:255], v[172:175]
  v_lshlrev_b32 v140, 16, v254
  v_and_b32 v141, 0xffff0000, v254
  v_lshlrev_b32 v142, 16, v255
  v_and_b32 v143, 0xffff0000, v255
  s_nop 7
  v_pk_add_f32 v[160:161], v[160:161], v[164:165]
  v_pk_add_f32 v[162:163], v[162:163], v[166:167]
  v_cndmask_b32 v160, v160, v161, s[82:83]
  v_cndmask_b32 v162, v162, v163, s[82:83]
  v_cndmask_b32 v148, v160, v162, s[84:85]
  v_pk_add_f32 v[168:169], v[168:169], v[172:173]
  v_pk_add_f32 v[170:171], v[170:171], v[174:175]
  v_cndmask_b32 v168, v168, v169, s[82:83]
  v_cndmask_b32 v170, v170, v171, s[82:83]
  v_cndmask_b32 v150, v168, v170, s[84:85]
  v_mov_b32 v144, v152
  v_mov_b32 v146, v156
  s_nop 1
  v_add_f32_dpp v144, v144, v144 quad_perm:[1,0,3,2] row_mask:0xf bank_mask:0xf
  v_add_f32_dpp v146, v146, v146 quad_perm:[1,0,3,2] row_mask:0xf bank_mask:0xf
  v_add_f32_dpp v148, v148, v148 quad_perm:[1,0,3,2] row_mask:0xf bank_mask:0xf
  v_add_f32_dpp v150, v150, v150 quad_perm:[1,0,3,2] row_mask:0xf bank_mask:0xf
  v_add_f32_dpp v144, v144, v144 quad_perm:[2,3,0,1] row_mask:0xf bank_mask:0xf
  v_add_f32_dpp v146, v146, v146 quad_perm:[2,3,0,1] row_mask:0xf bank_mask:0xf
  v_add_f32_dpp v148, v148, v148 quad_perm:[2,3,0,1] row_mask:0xf bank_mask:0xf
  v_add_f32_dpp v150, v150, v150 quad_perm:[2,3,0,1] row_mask:0xf bank_mask:0xf
  v_add_f32_dpp v144, v144, v144 row_half_mirror row_mask:0xf bank_mask:0xf
  v_add_f32_dpp v146, v146, v146 row_half_mirror row_mask:0xf bank_mask:0xf
  v_add_f32_dpp v148, v148, v148 row_half_mirror row_mask:0xf bank_mask:0xf
  v_add_f32_dpp v150, v150, v150 row_half_mirror row_mask:0xf bank_mask:0xf
  v_mul_f32 v144, 0xbb000000, v144
  v_mul_f32 v148, 0x3b000000, v148
  v_fma_f32 v148, -v144, v144, v148
  v_max_f32 v148, 0, v148
  v_add_f32 v148, 0x3727c5ac, v148
  v_rsq_f32 v148, v148
  s_nop 0
  v_mul_f32 v144, v144, v148
  v_mov_b32 v149, v148
  v_mov_b32 v145, v144
  v_mul_f32 v146, 0xbb000000, v146
  v_mul_f32 v150, 0x3b000000, v150
  v_fma_f32 v150, -v146, v146, v150
  v_max_f32 v150, 0, v150
  v_add_f32 v150, 0x3727c5ac, v150
  v_rsq_f32 v150, v150
  s_nop 0
  v_mul_f32 v146, v146, v150
  v_mov_b32 v151, v150
  v_mov_b32 v147, v146
  v_pk_fma_f32 v[16:17], v[16:17], v[148:149], v[144:145]
  v_pk_fma_f32 v[18:19], v[18:19], v[148:149], v[144:145]
  v_pk_fma_f32 v[20:21], v[20:21], v[148:149], v[144:145]
  v_pk_fma_f32 v[22:23], v[22:23], v[148:149], v[144:145]
  v_cvt_pk_bf16_f32 v192, v16, v17
  v_cvt_pk_bf16_f32 v193, v18, v19
  v_cvt_pk_bf16_f32 v194, v20, v21
  v_cvt_pk_bf16_f32 v195, v22, v23
  ds_write_b128 v6, v[192:195] offset:0
  s_add_u32 m0, s56, 25536
  s_nop 0
  buffer_load_dwordx4 v8, s[12:15], s49 offen offset:64 lds
  v_pk_fma_f32 v[24:25], v[24:25], v[150:151], v[146:147]
  v_pk_fma_f32 v[26:27], v[26:27], v[150:151], v[146:147]
  v_pk_fma_f32 v[28:29], v[28:29], v[150:151], v[146:147]
  v_pk_fma_f32 v[30:31], v[30:31], v[150:151], v[146:147]
  v_cvt_pk_bf16_f32 v196, v24, v25
  v_cvt_pk_bf16_f32 v197, v26, v27
  v_cvt_pk_bf16_f32 v198, v28, v29
  v_cvt_pk_bf16_f32 v199, v30, v31
  ds_write_b128 v6, v[196:199] offset:4224
  v_pk_fma_f32 v[32:33], v[32:33], v[148:149], v[144:145]
  v_pk_fma_f32 v[34:35], v[34:35], v[148:149], v[144:145]
  v_pk_fma_f32 v[36:37], v[36:37], v[148:149], v[144:145]
  v_pk_fma_f32 v[38:39], v[38:39], v[148:149], v[144:145]
  v_cvt_pk_bf16_f32 v200, v32, v33
  v_cvt_pk_bf16_f32 v201, v34, v35
  v_cvt_pk_bf16_f32 v202, v36, v37
  v_cvt_pk_bf16_f32 v203, v38, v39
  ds_write_b128 v6, v[200:203] offset:128
  v_pk_fma_f32 v[40:41], v[40:41], v[150:151], v[146:147]
  v_pk_fma_f32 v[42:43], v[42:43], v[150:151], v[146:147]
  v_pk_fma_f32 v[44:45], v[44:45], v[150:151], v[146:147]
  v_pk_fma_f32 v[46:47], v[46:47], v[150:151], v[146:147]
  v_cvt_pk_bf16_f32 v204, v40, v41
  v_cvt_pk_bf16_f32 v205, v42, v43
  v_cvt_pk_bf16_f32 v206, v44, v45
  v_cvt_pk_bf16_f32 v207, v46, v47
  ds_write_b128 v6, v[204:207] offset:4096
  v_pk_fma_f32 v[48:49], v[48:49], v[148:149], v[144:145]
  v_pk_fma_f32 v[50:51], v[50:51], v[148:149], v[144:145]
  v_pk_fma_f32 v[52:53], v[52:53], v[148:149], v[144:145]
  v_pk_fma_f32 v[54:55], v[54:55], v[148:149], v[144:145]
  v_cvt_pk_bf16_f32 v208, v48, v49
  v_cvt_pk_bf16_f32 v209, v50, v51
  v_cvt_pk_bf16_f32 v210, v52, v53
  v_cvt_pk_bf16_f32 v211, v54, v55
  ds_write_b128 v6, v[208:211] offset:256
  v_pk_fma_f32 v[56:57], v[56:57], v[150:151], v[146:147]
  v_pk_fma_f32 v[58:59], v[58:59], v[150:151], v[146:147]
  v_pk_fma_f32 v[60:61], v[60:61], v[150:151], v[146:147]
  v_pk_fma_f32 v[62:63], v[62:63], v[150:151], v[146:147]
  v_cvt_pk_bf16_f32 v212, v56, v57
  v_cvt_pk_bf16_f32 v213, v58, v59
  v_cvt_pk_bf16_f32 v214, v60, v61
  v_cvt_pk_bf16_f32 v215, v62, v63
  ds_write_b128 v6, v[212:215] offset:4480
  v_pk_fma_f32 v[64:65], v[64:65], v[148:149], v[144:145]
  v_pk_fma_f32 v[66:67], v[66:67], v[148:149], v[144:145]
  v_pk_fma_f32 v[68:69], v[68:69], v[148:149], v[144:145]
  v_pk_fma_f32 v[70:71], v[70:71], v[148:149], v[144:145]
  v_cvt_pk_bf16_f32 v216, v64, v65
  v_cvt_pk_bf16_f32 v217, v66, v67
  v_cvt_pk_bf16_f32 v218, v68, v69
  v_cvt_pk_bf16_f32 v219, v70, v71
  ds_write_b128 v6, v[216:219] offset:384
  v_pk_fma_f32 v[72:73], v[72:73], v[150:151], v[146:147]
  v_pk_fma_f32 v[74:75], v[74:75], v[150:151], v[146:147]
  v_pk_fma_f32 v[76:77], v[76:77], v[150:151], v[146:147]
  v_pk_fma_f32 v[78:79], v[78:79], v[150:151], v[146:147]
  v_cvt_pk_bf16_f32 v220, v72, v73
  v_cvt_pk_bf16_f32 v221, v74, v75
  v_cvt_pk_bf16_f32 v222, v76, v77
  v_cvt_pk_bf16_f32 v223, v78, v79
  ds_write_b128 v6, v[220:223] offset:4352
  s_add_u32 m0, s56, 26624
  s_nop 0
  buffer_load_dwordx4 v8, s[12:15], s50 offen lds
  v_mov_b32 v204, v7
  v_xor_b32 v205, 64, v7
  v_xor_b32 v206, 128, v7
  v_xor_b32 v207, 192, v7
  s_waitcnt lgkmcnt(0)
  v_mov_b32 v208, v144
  v_mov_b32 v209, v145
  v_mov_b32 v210, v146
  v_mov_b32 v211, v147
  v_mov_b32 v212, v148
  v_mov_b32 v213, v149
  v_mov_b32 v214, v150
  v_mov_b32 v215, v151
  s_mul_i32 s47, s7, 0x85ebca6b
  s_add_u32 s47, s47, s6
  s_add_u32 s7, s47, 0x1234567
  s_mul_i32 s6, s6, 0x9e3779b1
  s_add_u32 s6, s6, 0x7f4a7c15
  s_waitcnt vmcnt(3)
  s_barrier
  ds_read_b128 v[16:19], v204 offset:0
  ds_read_b128 v[20:23], v204 offset:8192
  ds_read_b64_tr_b16 v[168:169], v11 offset:0
  ds_read_b64_tr_b16 v[170:171], v11 offset:256
  ds_read_b64_tr_b16 v[172:173], v11 offset:1024
  ds_read_b64_tr_b16 v[174:175], v11 offset:1280
  ds_read_b64_tr_b16 v[176:177], v11 offset:2048
  ds_read_b64_tr_b16 v[178:179], v11 offset:2304
  ds_read_b128 v[24:27], v205 offset:0
  ds_read_b128 v[28:31], v205 offset:8192
  ds_read_b64_tr_b16 v[180:181], v11 offset:6144
  ds_read_b64_tr_b16 v[182:183], v11 offset:6400
  ds_read_b64_tr_b16 v[184:185], v11 offset:7168
  ds_read_b64_tr_b16 v[186:187], v11 offset:7424
  ds_read_b64_tr_b16 v[188:189], v11 offset:8192
  ds_read_b64_tr_b16 v[190:191], v11 offset:8448
  s_cmp_eq_u32 s44, 0
  s_cbranch_scc1 L_pr
  s_setprio 1
L_pr:
  s_waitcnt lgkmcnt(8)
  v_mfma_f32_16x16x32_bf16 v[144:147], v[168:171], v[16:19], 0
  ds_read_b64_tr_b16 v[192:193], v11 offset:12288
  v_pk_fma_f32 v[80:81], v[80:81], v[212:213], v[208:209]
  v_pk_fma_f32 v[82:83], v[82:83], v[212:213], v[208:209]
  v_pk_fma_f32 v[84:85], v[84:85], v[212:213], v[208:209]
  ds_read_b128 v[32:35], v206 offset:0
  ds_read_b128 v[36:39], v206 offset:8192
  v_mfma_f32_16x16x32_bf16 v[148:151], v[168:171], v[20:23], 0
  ds_read_b64_tr_b16 v[194:195], v11 offset:12544
  v_pk_fma_f32 v[86:87], v[86:87], v[212:213], v[208:209]
  v_cvt_pk_bf16_f32 v224, v80, v81
  v_cvt_pk_bf16_f32 v225, v82, v83
  v_mfma_f32_16x16x32_bf16 v[152:155], v[172:175], v[16:19], 0
  ds_read_b64_tr_b16 v[196:197], v11 offset:13312
  s_add_u32 s49, s59, 4
  s_and_b32 s49, s49, 7
  s_lshl_b32 s49, s49, 2
  s_add_u32 s49, s49, s43
  s_mul_i32 s49, s49, 49152
  s_add_u32 s50, s49, s99
  s_add_u32 s49, s49, s98
  s_add_u32 m0, s56, 49152
  s_nop 0
  buffer_load_dwordx4 v8, s[12:15], s49 offen offset:0 lds
  v_cvt_pk_bf16_f32 v226, v84, v85
  v_cvt_pk_bf16_f32 v227, v86, v87
  v_pk_fma_f32 v[88:89], v[88:89], v[214:215], v[210:211]
  ds_read_b128 v[40:43], v207 offset:0
  ds_read_b128 v[44:47], v207 offset:8192
  v_mfma_f32_16x16x32_bf16 v[156:159], v[172:175], v[20:23], 0
  ds_read_b64_tr_b16 v[198:199], v11 offset:13568
  v_pk_fma_f32 v[90:91], v[90:91], v[214:215], v[210:211]
  v_pk_fma_f32 v[92:93], v[92:93], v[214:215], v[210:211]
  v_pk_fma_f32 v[94:95], v[94:95], v[214:215], v[210:211]
  v_mfma_f32_16x16x32_bf16 v[160:163], v[16:19], v[176:179], 0
  ds_read_b64_tr_b16 v[200:201], v11 offset:14336
  v_cvt_pk_bf16_f32 v228, v88, v89
  v_cvt_pk_bf16_f32 v229, v90, v91
  ds_read_b128 v[48:51], v204 offset:256
  ds_read_b128 v[52:55], v204 offset:8448
  v_mfma_f32_16x16x32_bf16 v[164:167], v[20:23], v[176:179], 0
  ds_read_b64_tr_b16 v[202:203], v11 offset:14592
  v_cvt_pk_bf16_f32 v230, v92, v93
  v_cvt_pk_bf16_f32 v231, v94, v95
  s_waitcnt lgkmcnt(12)
  v_mfma_f32_16x16x32_bf16 v[144:147], v[180:183], v[24:27], v[144:147]
  ds_read_b64_tr_b16 v[168:169], v11 offset:18432
  v_pk_fma_f32 v[96:97], v[96:97], v[212:213], v[208:209]
  v_pk_fma_f32 v[98:99], v[98:99], v[212:213], v[208:209]
  v_pk_fma_f32 v[100:101], v[100:101], v[212:213], v[208:209]
  ds_read_b128 v[56:59], v205 offset:256
  ds_read_b128 v[60:63], v205 offset:8448
  v_mfma_f32_16x16x32_bf16 v[148:151], v[180:183], v[28:31], v[148:151]
  ds_read_b64_tr_b16 v[170:171], v11 offset:18688
  v_pk_fma_f32 v[102:103], v[102:103], v[212:213], v[208:209]
  v_cvt_pk_bf16_f32 v232, v96, v97
  v_cvt_pk_bf16_f32 v233, v98, v99
  v_mfma_f32_16x16x32_bf16 v[152:155], v[184:187], v[24:27], v[152:155]
  ds_read_b64_tr_b16 v[172:173], v11 offset:19456
  s_add_u32 m0, s56, 50112
  s_nop 0
  buffer_load_dwordx4 v8, s[12:15], s49 offen offset:64 lds
  v_cvt_pk_bf16_f32 v234, v100, v101
  v_cvt_pk_bf16_f32 v235, v102, v103
  v_pk_fma_f32 v[104:105], v[104:105], v[214:215], v[210:211]
  ds_read_b128 v[64:67], v206 offset:256
  ds_read_b128 v[68:71], v206 offset:8448
  v_mfma_f32_16x16x32_bf16 v[156:159], v[184:187], v[28:31], v[156:159]
  ds_read_b64_tr_b16 v[174:175], v11 offset:19712
  v_pk_fma_f32 v[106:107], v[106:107], v[214:215], v[210:211]
  v_pk_fma_f32 v[108:109], v[108:109], v[214:215], v[210:211]
  v_pk_fma_f32 v[110:111], v[110:111], v[214:215], v[210:211]
  v_mfma_f32_16x16x32_bf16 v[160:163], v[24:27], v[188:191], v[160:163]
  ds_read_b64_tr_b16 v[176:177], v11 offset:20480
  v_cvt_pk_bf16_f32 v236, v104, v105
  v_cvt_pk_bf16_f32 v237, v106, v107
  ds_read_b128 v[72:75], v207 offset:256
  ds_read_b128 v[76:79], v207 offset:8448
  v_mfma_f32_16x16x32_bf16 v[164:167], v[28:31], v[188:191], v[164:167]
  ds_read_b64_tr_b16 v[178:179], v11 offset:20736
  v_cvt_pk_bf16_f32 v238, v108, v109
  v_cvt_pk_bf16_f32 v239, v110, v111
  s_waitcnt lgkmcnt(1)
  s_waitcnt vmcnt(2)
  s_barrier
  v_mfma_f32_16x16x32_bf16 v[144:147], v[192:195], v[32:35], v[144:147]
  ds_read_b64_tr_b16 v[180:181], v11 offset:24576
  v_pk_fma_f32 v[112:113], v[112:113], v[212:213], v[208:209]
  v_pk_fma_f32 v[114:115], v[114:115], v[212:213], v[208:209]
  v_pk_fma_f32 v[116:117], v[116:117], v[212:213], v[208:209]
  v_mfma_f32_16x16x32_bf16 v[148:151], v[192:195], v[36:39], v[148:151]
  ds_read_b64_tr_b16 v[182:183], v11 offset:24832
  v_pk_fma_f32 v[118:119], v[118:119], v[212:213], v[208:209]
  v_cvt_pk_bf16_f32 v240, v112, v113
  v_cvt_pk_bf16_f32 v241, v114, v115
  ds_write_b128 v6, v[224:227] offset:0
  v_mfma_f32_16x16x32_bf16 v[152:155], v[196:199], v[32:35], v[152:155]
  ds_read_b64_tr_b16 v[184:185], v11 offset:25600
  s_add_u32 m0, s56, 51200
  s_nop 0
  buffer_load_dwordx4 v8, s[12:15], s50 offen lds
  v_cvt_pk_bf16_f32 v242, v116, v117
  v_cvt_pk_bf16_f32 v243, v118, v119
  v_pk_fma_f32 v[120:121], v[120:121], v[214:215], v[210:211]
  v_mfma_f32_16x16x32_bf16 v[156:159], v[196:199], v[36:39], v[156:159]
  ds_read_b64_tr_b16 v[186:187], v11 offset:25856
  v_pk_fma_f32 v[122:123], v[122:123], v[214:215], v[210:211]
  v_pk_fma_f32 v[124:125], v[124:125], v[214:215], v[210:211]
  v_pk_fma_f32 v[126:127], v[126:127], v[214:215], v[210:211]
  ds_write_b128 v6, v[228:231] offset:4224
  v_mfma_f32_16x16x32_bf16 v[160:163], v[32:35], v[200:203], v[160:163]
  ds_read_b64_tr_b16 v[188:189], v11 offset:26624
  v_cvt_pk_bf16_f32 v244, v120, v121
  v_cvt_pk_bf16_f32 v245, v122, v123
  v_mfma_f32_16x16x32_bf16 v[164:167], v[36:39], v[200:203], v[164:167]
  ds_read_b64_tr_b16 v[190:191], v11 offset:26880
  v_cvt_pk_bf16_f32 v246, v124, v125
  v_cvt_pk_bf16_f32 v247, v126, v127
  s_waitcnt lgkmcnt(8)
  v_mfma_f32_16x16x32_bf16 v[144:147], v[168:171], v[40:43], v[144:147]
  ds_read_b64_tr_b16 v[192:193], v11 offset:30720
  v_pk_fma_f32 v[128:129], v[128:129], v[212:213], v[208:209]
  v_pk_fma_f32 v[130:131], v[130:131], v[212:213], v[208:209]
  v_pk_fma_f32 v[132:133], v[132:133], v[212:213], v[208:209]
  v_mfma_f32_16x16x32_bf16 v[148:151], v[168:171], v[44:47], v[148:151]
  ds_read_b64_tr_b16 v[194:195], v11 offset:30976
  v_pk_fma_f32 v[134:135], v[134:135], v[212:213], v[208:209]
  v_cvt_pk_bf16_f32 v248, v128, v129
  v_cvt_pk_bf16_f32 v249, v130, v131
  ds_write_b128 v6, v[232:235] offset:128
  v_mfma_f32_16x16x32_bf16 v[152:155], v[172:175], v[40:43], v[152:155]
  ds_read_b64_tr_b16 v[196:197], v11 offset:31744
  s_add_u32 s49, s59, 6
  s_and_b32 s49, s49, 7
  s_lshl_b32 s49, s49, 2
  s_add_u32 s49, s49, s43
  s_mul_i32 s49, s49, 49152
  s_add_u32 s50, s49, s99
  s_add_u32 s49, s49, s98
  s_add_u32 m0, s56, 73728
  s_nop 0
  buffer_load_dwordx4 v8, s[12:15], s49 offen offset:0 lds
  v_cvt_pk_bf16_f32 v250, v132, v133
  v_cvt_pk_bf16_f32 v251, v134, v135
  v_pk_fma_f32 v[136:137], v[136:137], v[214:215], v[210:211]
  v_mfma_f32_16x16x32_bf16 v[156:159], v[172:175], v[44:47], v[156:159]
  ds_read_b64_tr_b16 v[198:199], v11 offset:32000
  v_pk_fma_f32 v[138:139], v[138:139], v[214:215], v[210:211]
  v_pk_fma_f32 v[140:141], v[140:141], v[214:215], v[210:211]
  v_pk_fma_f32 v[142:143], v[142:143], v[214:215], v[210:211]
  ds_write_b128 v6, v[236:239] offset:4096
  v_mfma_f32_16x16x32_bf16 v[160:163], v[40:43], v[176:179], v[160:163]
  ds_read_b64_tr_b16 v[200:201], v11 offset:32768
  v_cvt_pk_bf16_f32 v252, v136, v137
  v_cvt_pk_bf16_f32 v253, v138, v139
  v_mfma_f32_16x16x32_bf16 v[164:167], v[44:47], v[176:179], v[164:167]
  ds_read_b64_tr_b16 v[202:203], v11 offset:33024
  v_cvt_pk_bf16_f32 v254, v140, v141
  v_cvt_pk_bf16_f32 v255, v142, v143
  s_waitcnt lgkmcnt(8)
  v_mfma_f32_16x16x32_bf16 v[144:147], v[180:183], v[48:51], v[144:147]
  ds_read_b64_tr_b16 v[168:169], v11 offset:36864
  v_mfma_f32_16x16x32_bf16 v[148:151], v[180:183], v[52:55], v[148:151]
  ds_read_b64_tr_b16 v[170:171], v11 offset:37120
  ds_write_b128 v6, v[240:243] offset:256
  v_mfma_f32_16x16x32_bf16 v[152:155], v[184:187], v[48:51], v[152:155]
  ds_read_b64_tr_b16 v[172:173], v11 offset:37888
  s_add_u32 m0, s56, 74688
  s_nop 0
  buffer_load_dwordx4 v8, s[12:15], s49 offen offset:64 lds
  v_mfma_f32_16x16x32_bf16 v[156:159], v[184:187], v[52:55], v[156:159]
  ds_read_b64_tr_b16 v[174:175], v11 offset:38144
  ds_write_b128 v6, v[244:247] offset:4480
  v_mfma_f32_16x16x32_bf16 v[160:163], v[48:51], v[188:191], v[160:163]
  ds_read_b64_tr_b16 v[176:177], v11 offset:38912
  v_mfma_f32_16x16x32_bf16 v[164:167], v[52:55], v[188:191], v[164:167]
  ds_read_b64_tr_b16 v[178:179], v11 offset:39168
  s_waitcnt lgkmcnt(8)
  v_mfma_f32_16x16x32_bf16 v[144:147], v[192:195], v[56:59], v[144:147]
  ds_read_b64_tr_b16 v[180:181], v11 offset:43008
  v_mfma_f32_16x16x32_bf16 v[148:151], v[192:195], v[60:63], v[148:151]
  ds_read_b64_tr_b16 v[182:183], v11 offset:43264
  ds_write_b128 v6, v[248:251] offset:384
  v_mfma_f32_16x16x32_bf16 v[152:155], v[196:199], v[56:59], v[152:155]
  ds_read_b64_tr_b16 v[184:185], v11 offset:44032
  s_add_u32 m0, s56, 75776
  s_nop 0
  buffer_load_dwordx4 v8, s[12:15], s50 offen lds
  v_mfma_f32_16x16x32_bf16 v[156:159], v[196:199], v[60:63], v[156:159]
  ds_read_b64_tr_b16 v[186:187], v11 offset:44288
  ds_write_b128 v6, v[252:255] offset:4352
  v_mfma_f32_16x16x32_bf16 v[160:163], v[56:59], v[200:203], v[160:163]
  ds_read_b64_tr_b16 v[188:189], v11 offset:45056
  v_mfma_f32_16x16x32_bf16 v[164:167], v[60:63], v[200:203], v[164:167]
  ds_read_b64_tr_b16 v[190:191], v11 offset:45312
  s_waitcnt lgkmcnt(2)
  s_waitcnt vmcnt(3)
  s_barrier
  v_mfma_f32_16x16x32_bf16 v[144:147], v[168:171], v[64:67], v[144:147]
  ds_read_b64_tr_b16 v[192:193], v12 offset:0
  ds_read_b128 v[80:83], v204 offset:0
  ds_read_b128 v[84:87], v204 offset:8192
  v_mfma_f32_16x16x32_bf16 v[148:151], v[168:171], v[68:71], v[148:151]
  ds_read_b64_tr_b16 v[194:195], v12 offset:256
  v_mfma_f32_16x16x32_bf16 v[152:155], v[172:175], v[64:67], v[152:155]
  ds_read_b64_tr_b16 v[196:197], v12 offset:1024
  s_add_u32 s49, s59, 0
  s_and_b32 s49, s49, 7
  s_lshl_b32 s49, s49, 2
  s_add_u32 s49, s49, s43
  s_mul_i32 s49, s49, 44032
  s_add_u32 s49, s49, s100
  s_add_u32 m0, s56, 0
  s_nop 0
  buffer_load_dwordx4 v9, s[20:23], s49 offen offset:0 lds
  ds_read_b128 v[88:91], v205 offset:0
  ds_read_b128 v[92:95], v205 offset:8192
  v_mfma_f32_16x16x32_bf16 v[156:159], v[172:175], v[68:71], v[156:159]
  ds_read_b64_tr_b16 v[198:199], v12 offset:1280
  v_mfma_f32_16x16x32_bf16 v[160:163], v[64:67], v[176:179], v[160:163]
  ds_read_b64_tr_b16 v[200:201], v12 offset:2048
  v_mfma_f32_16x16x32_bf16 v[164:167], v[68:71], v[176:179], v[164:167]
  ds_read_b64_tr_b16 v[202:203], v12 offset:2304
  s_waitcnt lgkmcnt(10)
  v_mfma_f32_16x16x32_bf16 v[144:147], v[180:183], v[72:75], v[144:147]
  ds_read_b64_tr_b16 v[168:169], v12 offset:6144
  ds_read_b128 v[96:99], v206 offset:0
  ds_read_b128 v[100:103], v206 offset:8192
  v_mfma_f32_16x16x32_bf16 v[148:151], v[180:183], v[76:79], v[148:151]
  ds_read_b64_tr_b16 v[170:171], v12 offset:6400
  v_mfma_f32_16x16x32_bf16 v[152:155], v[184:187], v[72:75], v[152:155]
  ds_read_b64_tr_b16 v[172:173], v12 offset:7168
  s_add_u32 m0, s56, 960
  s_nop 0
  buffer_load_dwordx4 v9, s[20:23], s49 offen offset:64 lds
  ds_read_b128 v[104:107], v207 offset:0
  ds_read_b128 v[108:111], v207 offset:8192
  v_mfma_f32_16x16x32_bf16 v[156:159], v[184:187], v[76:79], v[156:159]
  ds_read_b64_tr_b16 v[174:175], v12 offset:7424
  v_mfma_f32_16x16x32_bf16 v[160:163], v[72:75], v[188:191], v[160:163]
  ds_read_b64_tr_b16 v[176:177], v12 offset:8192
  v_mfma_f32_16x16x32_bf16 v[164:167], v[76:79], v[188:191], v[164:167]
  ds_read_b64_tr_b16 v[178:179], v12 offset:8448
  s_waitcnt lgkmcnt(10)
  v_mfma_f32_16x16x32_bf16 v[144:147], v[192:195], v[80:83], v[144:147]
  ds_read_b64_tr_b16 v[180:181], v12 offset:12288
  ds_read_b128 v[112:115], v204 offset:256
  ds_read_b128 v[116:119], v204 offset:8448
  v_mfma_f32_16x16x32_bf16 v[148:151], v[192:195], v[84:87], v[148:151]
  ds_read_b64_tr_b16 v[182:183], v12 offset:12544
  v_mfma_f32_16x16x32_bf16 v[152:155], v[196:199], v[80:83], v[152:155]
  ds_read_b64_tr_b16 v[184:185], v12 offset:13312
  s_add_u32 m0, s56, 1920
  s_nop 0
  buffer_load_dwordx4 v9, s[20:23], s49 offen offset:128 lds
  v_mfma_f32_16x16x32_bf16 v[156:159], v[196:199], v[84:87], v[156:159]
  ds_read_b64_tr_b16 v[186:187], v12 offset:13568
  v_mfma_f32_16x16x32_bf16 v[160:163], v[80:83], v[200:203], v[160:163]
  ds_read_b64_tr_b16 v[188:189], v12 offset:14336
  v_mfma_f32_16x16x32_bf16 v[164:167], v[84:87], v[200:203], v[164:167]
  ds_read_b64_tr_b16 v[190:191], v12 offset:14592
  s_waitcnt lgkmcnt(8)
  v_mfma_f32_16x16x32_bf16 v[144:147], v[168:171], v[88:91], v[144:147]
  ds_read_b64_tr_b16 v[192:193], v12 offset:18432
  ds_read_b128 v[120:123], v205 offset:256
  ds_read_b128 v[124:127], v205 offset:8448
  v_mfma_f32_16x16x32_bf16 v[148:151], v[168:171], v[92:95], v[148:151]
  ds_read_b64_tr_b16 v[194:195], v12 offset:18688
  v_mfma_f32_16x16x32_bf16 v[152:155], v[172:175], v[88:91], v[152:155]
  ds_read_b64_tr_b16 v[196:197], v12 offset:19456
  v_mfma_f32_16x16x32_bf16 v[156:159], v[172:175], v[92:95], v[156:159]
  ds_read_b64_tr_b16 v[198:199], v12 offset:19712
  v_mfma_f32_16x16x32_bf16 v[160:163], v[88:91], v[176:179], v[160:163]
  ds_read_b64_tr_b16 v[200:201], v12 offset:20480
  v_mfma_f32_16x16x32_bf16 v[164:167], v[92:95], v[176:179], v[164:167]
  ds_read_b64_tr_b16 v[202:203], v12 offset:20736
  s_waitcnt vmcnt(3)
  s_barrier
  s_waitcnt lgkmcnt(8)
  v_mfma_f32_16x16x32_bf16 v[144:147], v[180:183], v[96:99], v[144:147]
  ds_read_b64_tr_b16 v[168:169], v12 offset:24576
  ds_read_b128 v[128:131], v206 offset:256
  ds_read_b128 v[132:135], v206 offset:8448
  v_mfma_f32_16x16x32_bf16 v[148:151], v[180:183], v[100:103], v[148:151]
  ds_read_b64_tr_b16 v[170:171], v12 offset:24832
  v_mfma_f32_16x16x32_bf16 v[152:155], v[184:187], v[96:99], v[152:155]
  ds_read_b64_tr_b16 v[172:173], v12 offset:25600
  s_add_u32 s49, s59, 2
  s_and_b32 s49, s49, 7
  s_lshl_b32 s49, s49, 2
  s_add_u32 s49, s49, s43
  s_mul_i32 s49, s49, 44032
  s_add_u32 s49, s49, s100
  s_add_u32 m0, s56, 24576
  s_nop 0
  buffer_load_dwordx4 v9, s[20:23], s49 offen offset:0 lds
  v_mfma_f32_16x16x32_bf16 v[156:159], v[184:187], v[100:103], v[156:159]
  ds_read_b64_tr_b16 v[174:175], v12 offset:25856
  v_mfma_f32_16x16x32_bf16 v[160:163], v[96:99], v[188:191], v[160:163]
  ds_read_b64_tr_b16 v[176:177], v12 offset:26624
  v_mfma_f32_16x16x32_bf16 v[164:167], v[100:103], v[188:191], v[164:167]
  ds_read_b64_tr_b16 v[178:179], v12 offset:26880
  s_waitcnt lgkmcnt(8)
  v_mfma_f32_16x16x32_bf16 v[144:147], v[192:195], v[104:107], v[144:147]
  ds_read_b64_tr_b16 v[180:181], v12 offset:30720
  ds_read_b128 v[136:139], v207 offset:256
  ds_read_b128 v[140:143], v207 offset:8448
  v_mfma_f32_16x16x32_bf16 v[148:151], v[192:195], v[108:111], v[148:151]
  ds_read_b64_tr_b16 v[182:183], v12 offset:30976
  v_mfma_f32_16x16x32_bf16 v[152:155], v[196:199], v[104:107], v[152:155]
  ds_read_b64_tr_b16 v[184:185], v12 offset:31744
  s_add_u32 m0, s56, 25536
  s_nop 0
  buffer_load_dwordx4 v9, s[20:23], s49 offen offset:64 lds
  v_mfma_f32_16x16x32_bf16 v[156:159], v[196:199], v[108:111], v[156:159]
  ds_read_b64_tr_b16 v[186:187], v12 offset:32000
  v_mfma_f32_16x16x32_bf16 v[160:163], v[104:107], v[200:203], v[160:163]
  ds_read_b64_tr_b16 v[188:189], v12 offset:32768
  v_mfma_f32_16x16x32_bf16 v[164:167], v[108:111], v[200:203], v[164:167]
  ds_read_b64_tr_b16 v[190:191], v12 offset:33024
  s_waitcnt lgkmcnt(8)
  v_mfma_f32_16x16x32_bf16 v[144:147], v[168:171], v[112:115], v[144:147]
  ds_read_b64_tr_b16 v[192:193], v12 offset:36864
  v_mfma_f32_16x16x32_bf16 v[148:151], v[168:171], v[116:119], v[148:151]
  ds_read_b64_tr_b16 v[194:195], v12 offset:37120
  v_mfma_f32_16x16x32_bf16 v[152:155], v[172:175], v[112:115], v[152:155]
  ds_read_b64_tr_b16 v[196:197], v12 offset:37888
  s_add_u32 m0, s56, 26496
  s_nop 0
  buffer_load_dwordx4 v9, s[20:23], s49 offen offset:128 lds
  v_mfma_f32_16x16x32_bf16 v[156:159], v[172:175], v[116:119], v[156:159]
  ds_read_b64_tr_b16 v[198:199], v12 offset:38144
  v_mfma_f32_16x16x32_bf16 v[160:163], v[112:115], v[176:179], v[160:163]
  ds_read_b64_tr_b16 v[200:201], v12 offset:38912
  v_mfma_f32_16x16x32_bf16 v[164:167], v[116:119], v[176:179], v[164:167]
  ds_read_b64_tr_b16 v[202:203], v12 offset:39168
  s_waitcnt lgkmcnt(6)
  v_mfma_f32_16x16x32_bf16 v[144:147], v[180:183], v[120:123], v[144:147]
  ds_read_b64_tr_b16 v[168:169], v12 offset:43008
  v_mfma_f32_16x16x32_bf16 v[148:151], v[180:183], v[124:127], v[148:151]
  ds_read_b64_tr_b16 v[170:171], v12 offset:43264
  v_mfma_f32_16x16x32_bf16 v[152:155], v[184:187], v[120:123], v[152:155]
  ds_read_b64_tr_b16 v[172:173], v12 offset:44032
  v_mfma_f32_16x16x32_bf16 v[156:159], v[184:187], v[124:127], v[156:159]
  ds_read_b64_tr_b16 v[174:175], v12 offset:44288
  v_mfma_f32_16x16x32_bf16 v[160:163], v[120:123], v[188:191], v[160:163]
  ds_read_b64_tr_b16 v[176:177], v12 offset:45056
  v_mfma_f32_16x16x32_bf16 v[164:167], v[124:127], v[188:191], v[164:167]
  ds_read_b64_tr_b16 v[178:179], v12 offset:45312
  s_waitcnt vmcnt(3)
  s_barrier
  v_mov_b32 v3, 160768
  v_mov_b32 v10, 0
  ds_write_b32 v3, v10
  ds_write_b32 v3, v10 offset:4
  ds_write_b32 v3, v10 offset:8
  s_waitcnt lgkmcnt(9)
  v_mfma_f32_16x16x32_bf16 v[144:147], v[192:195], v[128:131], v[144:147]
  ds_read_b64_tr_b16 v[180:181], v11 offset:0
  v_mfma_f32_16x16x32_bf16 v[148:151], v[192:195], v[132:135], v[148:151]
  ds_read_b64_tr_b16 v[182:183], v11 offset:256
  v_mfma_f32_16x16x32_bf16 v[152:155], v[196:199], v[128:131], v[152:155]
  ds_read_b64_tr_b16 v[184:185], v11 offset:1024
  s_add_u32 s49, s59, 4
  s_and_b32 s49, s49, 7
  s_lshl_b32 s49, s49, 2
  s_add_u32 s49, s49, s43
  s_mul_i32 s49, s49, 44032
  s_add_u32 s49, s49, s100
  s_add_u32 m0, s56, 98304
  s_nop 0
  buffer_load_dwordx4 v9, s[20:23], s49 offen offset:0 lds
  v_mfma_f32_16x16x32_bf16 v[156:159], v[196:199], v[132:135], v[156:159]
  ds_read_b64_tr_b16 v[186:187], v11 offset:1280
  v_mfma_f32_16x16x32_bf16 v[160:163], v[128:131], v[200:203], v[160:163]
  ds_read_b64_tr_b16 v[188:189], v11 offset:2048
  v_mfma_f32_16x16x32_bf16 v[164:167], v[132:135], v[200:203], v[164:167]
  ds_read_b64_tr_b16 v[190:191], v11 offset:2304
  s_waitcnt lgkmcnt(9)
  v_mfma_f32_16x16x32_bf16 v[144:147], v[168:171], v[136:139], v[144:147]
  ds_read_b64_tr_b16 v[192:193], v11 offset:6144
  v_mfma_f32_16x16x32_bf16 v[148:151], v[168:171], v[140:143], v[148:151]
  ds_read_b64_tr_b16 v[194:195], v11 offset:6400
  v_mfma_f32_16x16x32_bf16 v[152:155], v[172:175], v[136:139], v[152:155]
  ds_read_b64_tr_b16 v[196:197], v11 offset:7168
  s_add_u32 m0, s56, 99264
  s_nop 0
  buffer_load_dwordx4 v9, s[20:23], s49 offen offset:64 lds
  v_mfma_f32_16x16x32_bf16 v[156:159], v[172:175], v[140:143], v[156:159]
  ds_read_b64_tr_b16 v[198:199], v11 offset:7424
  v_mfma_f32_16x16x32_bf16 v[160:163], v[136:139], v[176:179], v[160:163]
  ds_read_b64_tr_b16 v[200:201], v11 offset:8192
  v_mfma_f32_16x16x32_bf16 v[164:167], v[140:143], v[176:179], v[164:167]
  ds_read_b64_tr_b16 v[202:203], v11 offset:8448
  s_waitcnt lgkmcnt(6)
  v_mfma_f32_16x16x32_bf16 v[220:223], v[180:183], v[16:19], 0
  ds_read_b64_tr_b16 v[168:169], v11 offset:12288
  v_mfma_f32_16x16x32_bf16 v[224:227], v[180:183], v[20:23], 0
  ds_read_b64_tr_b16 v[170:171], v11 offset:12544
  v_mfma_f32_16x16x32_bf16 v[228:231], v[184:187], v[16:19], 0
  ds_read_b64_tr_b16 v[172:173], v11 offset:13312
  s_add_u32 m0, s56, 100224
  s_nop 0
  buffer_load_dwordx4 v9, s[20:23], s49 offen offset:128 lds
  v_mfma_f32_16x16x32_bf16 v[232:235], v[184:187], v[20:23], 0
  ds_read_b64_tr_b16 v[174:175], v11 offset:13568
  v_mfma_f32_16x16x32_bf16 v[236:239], v[188:191], v[16:19], 0
  ds_read_b64_tr_b16 v[176:177], v11 offset:14336
  v_mfma_f32_16x16x32_bf16 v[240:243], v[188:191], v[20:23], 0
  ds_read_b64_tr_b16 v[178:179], v11 offset:14592
  s_and_b32 s47, s41, 1
  s_cmp_eq_u32 s47, 0
  s_cselect_b32 s48, 0x3eb8aa3b, 1.0
  v_mul_f32 v144, s48, v144
  v_mul_f32 v145, s48, v145
  v_mul_f32 v146, s48, v146
  v_mul_f32 v147, s48, v147
  v_mul_f32 v148, s48, v148
  v_mul_f32 v149, s48, v149
  v_mul_f32 v150, s48, v150
  v_mul_f32 v151, s48, v151
  v_mul_f32 v152, s48, v152
  v_mul_f32 v153, s48, v153
  v_mul_f32 v154, s48, v154
  v_mul_f32 v155, s48, v155
  v_mul_f32 v156, s48, v156
  v_mul_f32 v157, s48, v157
  v_mul_f32 v158, s48, v158
  v_mul_f32 v159, s48, v159
  s_lshl_b32 s47, s47, 21
  s_lshl_b32 s48, s46, 15
  s_add_u32 s47, s47, s48
  s_lshr_b32 s50, s41, 1
  s_lshl_b32 s50, s50, 2
  s_add_u32 s50, s50, s44
  s_lshl_b32 s50, s50, 10
  s_add_u32 s47, s47, s50
  s_lshl_b32 s50, s41, 1
  s_add_u32 s50, s50, s44
  s_lshl_b32 s50, s50, 10
  s_add_u32 s48, s48, s50
  s_add_u32 s48, s48, 4194304
  v_cvt_pk_bf16_f32 v208, v144, v145
  v_cvt_pk_bf16_f32 v209, v146, v147
  v_cvt_pk_bf16_f32 v210, v148, v149
  v_cvt_pk_bf16_f32 v211, v150, v151
  s_nop 0
  v_permlane32_swap_b32 v208, v210
  v_permlane32_swap_b32 v209, v211
  buffer_store_dwordx4 v[208:211], v15, s[36:39], s47 offen offset:0 sc1
  v_cvt_pk_bf16_f32 v212, v152, v153
  v_cvt_pk_bf16_f32 v213, v154, v155
  v_cvt_pk_bf16_f32 v214, v156, v157
  v_cvt_pk_bf16_f32 v215, v158, v159
  s_nop 0
  v_permlane32_swap_b32 v212, v214
  v_permlane32_swap_b32 v213, v215
  buffer_store_dwordx4 v[212:215], v15, s[36:39], s47 offen offset:2048 sc1
  v_cvt_pk_bf16_f32 v216, v160, v161
  v_cvt_pk_bf16_f32 v217, v162, v163
  v_cvt_pk_bf16_f32 v218, v164, v165
  v_cvt_pk_bf16_f32 v219, v166, v167
  s_nop 0
  v_permlane32_swap_b32 v216, v218
  v_permlane32_swap_b32 v217, v219
  buffer_store_dwordx4 v[216:219], v14, s[36:39], s48 offen sc1
  s_add_u32 s49, s59, 6
  s_and_b32 s49, s49, 7
  s_lshl_b32 s49, s49, 2
  s_add_u32 s49, s49, s43
  s_mul_i32 s49, s49, 44032
  s_add_u32 s49, s49, s100
  s_add_u32 m0, s56, 122880
  s_nop 0
  buffer_load_dwordx4 v9, s[20:23], s49 offen offset:0 lds
  s_waitcnt lgkmcnt(6)
  v_mfma_f32_16x16x32_bf16 v[220:223], v[192:195], v[24:27], v[220:223]
  ds_read_b64_tr_b16 v[180:181], v11 offset:18432
  v_mfma_f32_16x16x32_bf16 v[224:227], v[192:195], v[28:31], v[224:227]
  ds_read_b64_tr_b16 v[182:183], v11 offset:18688
  v_mfma_f32_16x16x32_bf16 v[228:231], v[196:199], v[24:27], v[228:231]
  ds_read_b64_tr_b16 v[184:185], v11 offset:19456
  v_mfma_f32_16x16x32_bf16 v[232:235], v[196:199], v[28:31], v[232:235]
  ds_read_b64_tr_b16 v[186:187], v11 offset:19712
  v_mfma_f32_16x16x32_bf16 v[236:239], v[200:203], v[24:27], v[236:239]
  ds_read_b64_tr_b16 v[188:189], v11 offset:20480
  v_mfma_f32_16x16x32_bf16 v[240:243], v[200:203], v[28:31], v[240:243]
  ds_read_b64_tr_b16 v[190:191], v11 offset:20736
  s_waitcnt vmcnt(7)
  s_barrier
  s_waitcnt lgkmcnt(6)
  v_mfma_f32_16x16x32_bf16 v[220:223], v[168:171], v[32:35], v[220:223]
  ds_read_b64_tr_b16 v[192:193], v11 offset:24576
  v_mfma_f32_16x16x32_bf16 v[224:227], v[168:171], v[36:39], v[224:227]
  ds_read_b64_tr_b16 v[194:195], v11 offset:24832
  v_mfma_f32_16x16x32_bf16 v[228:231], v[172:175], v[32:35], v[228:231]
  ds_read_b64_tr_b16 v[196:197], v11 offset:25600
  s_add_u32 m0, s56, 123840
  s_nop 0
  buffer_load_dwordx4 v9, s[20:23], s49 offen offset:64 lds
  v_mfma_f32_16x16x32_bf16 v[232:235], v[172:175], v[36:39], v[232:235]
  ds_read_b64_tr_b16 v[198:199], v11 offset:25856
  v_mfma_f32_16x16x32_bf16 v[236:239], v[176:179], v[32:35], v[236:239]
  ds_read_b64_tr_b16 v[200:201], v11 offset:26624
  v_mfma_f32_16x16x32_bf16 v[240:243], v[176:179], v[36:39], v[240:243]
  ds_read_b64_tr_b16 v[202:203], v11 offset:26880
  s_waitcnt lgkmcnt(6)
  v_mfma_f32_16x16x32_bf16 v[220:223], v[180:183], v[40:43], v[220:223]
  ds_read_b64_tr_b16 v[168:169], v11 offset:30720
  v_mfma_f32_16x16x32_bf16 v[224:227], v[180:183], v[44:47], v[224:227]
  ds_read_b64_tr_b16 v[170:171], v11 offset:30976
  v_mfma_f32_16x16x32_bf16 v[228:231], v[184:187], v[40:43], v[228:231]
  ds_read_b64_tr_b16 v[172:173], v11 offset:31744
  s_add_u32 m0, s56, 124800
  s_nop 0
  buffer_load_dwordx4 v9, s[20:23], s49 offen offset:128 lds
  v_mfma_f32_16x16x32_bf16 v[232:235], v[184:187], v[44:47], v[232:235]
  ds_read_b64_tr_b16 v[174:175], v11 offset:32000
  v_mfma_f32_16x16x32_bf16 v[236:239], v[188:191], v[40:43], v[236:239]
  ds_read_b64_tr_b16 v[176:177], v11 offset:32768
  v_mfma_f32_16x16x32_bf16 v[240:243], v[188:191], v[44:47], v[240:243]
  ds_read_b64_tr_b16 v[178:179], v11 offset:33024
  s_waitcnt vmcnt(3)
  v_mov_b32 v3, 160776
  v_mov_b32 v10, 1
  s_mov_b64 exec, 1
  ds_add_rtn_u32 v10, v3, v10
  s_waitcnt lgkmcnt(0)
  s_mov_b64 exec, -1
  v_readfirstlane_b32 s47, v10
  s_nop 1
  s_cmp_lg_u32 s47, 7
  s_cbranch_scc1 L_f1
  s_mov_b64 exec, 1
  s_lshl_b32 s47, s55, 3
  s_add_u32 s47, s47, 14684160
  v_mov_b32 v4, s6
  v_mov_b32 v5, s7
  v_mov_b32 v3, 0
  buffer_store_dwordx2 v[4:5], v3, s[36:39], s47 offen sc1
  s_mov_b64 exec, -1
L_f1:
  s_waitcnt lgkmcnt(6)
  s_nop 2
  v_mfma_f32_16x16x32_bf16 v[220:223], v[192:195], v[48:51], v[220:223]
  ds_read_b64_tr_b16 v[180:181], v11 offset:36864
  v_mfma_f32_16x16x32_bf16 v[224:227], v[192:195], v[52:55], v[224:227]
  ds_read_b64_tr_b16 v[182:183], v11 offset:37120
  v_mfma_f32_16x16x32_bf16 v[228:231], v[196:199], v[48:51], v[228:231]
  ds_read_b64_tr_b16 v[184:185], v11 offset:37888
  v_mfma_f32_16x16x32_bf16 v[232:235], v[196:199], v[52:55], v[232:235]
  ds_read_b64_tr_b16 v[186:187], v11 offset:38144
  v_mfma_f32_16x16x32_bf16 v[236:239], v[200:203], v[48:51], v[236:239]
  ds_read_b64_tr_b16 v[188:189], v11 offset:38912
  v_mfma_f32_16x16x32_bf16 v[240:243], v[200:203], v[52:55], v[240:243]
  ds_read_b64_tr_b16 v[190:191], v11 offset:39168
  s_waitcnt lgkmcnt(6)
  s_lshr_b32 s47, s2, 3
  s_lshl_b32 s47, s47, 3
  s_add_u32 s47, s47, s42
  v_bfrev_b32 v3, 2
  s_mul_i32 s48, s47, 768
  v_add_u32 v252, s48, v14
  v_cmp_gt_u32 vcc, 48, v1
  s_nop 1
  v_cndmask_b32 v252, v3, v252, vcc
  s_mul_i32 s48, s47, 640
  v_add_u32 v253, s48, v14
  v_cmp_gt_u32 vcc, 40, v1
  s_nop 1
  v_cndmask_b32 v253, v3, v253, vcc
  s_lshl_b32 s48, s47, 11
  v_add_u32 v254, s48, v14
  v_mfma_f32_16x16x32_bf16 v[220:223], v[168:171], v[56:59], v[220:223]
  ds_read_b64_tr_b16 v[192:193], v11 offset:43008
  v_mfma_f32_16x16x32_bf16 v[224:227], v[168:171], v[60:63], v[224:227]
  ds_read_b64_tr_b16 v[194:195], v11 offset:43264
  v_mfma_f32_16x16x32_bf16 v[228:231], v[172:175], v[56:59], v[228:231]
  ds_read_b64_tr_b16 v[196:197], v11 offset:44032
  s_mov_b32 s50, 0
  buffer_load_dwordx4 v[248:251], v252, s[24:27], s50 offen offset:0
  v_mfma_f32_16x16x32_bf16 v[232:235], v[172:175], v[60:63], v[232:235]
  ds_read_b64_tr_b16 v[198:199], v11 offset:44288
  v_mfma_f32_16x16x32_bf16 v[236:239], v[176:179], v[56:59], v[236:239]
  ds_read_b64_tr_b16 v[200:201], v11 offset:45056
  v_mfma_f32_16x16x32_bf16 v[240:243], v[176:179], v[60:63], v[240:243]
  ds_read_b64_tr_b16 v[202:203], v11 offset:45312
  s_waitcnt vmcnt(4)
  s_barrier
  s_waitcnt lgkmcnt(6)
  v_mfma_f32_16x16x32_bf16 v[220:223], v[180:183], v[64:67], v[220:223]
  ds_read_b64_tr_b16 v[168:169], v13 offset:0
  v_mfma_f32_16x16x32_bf16 v[224:227], v[180:183], v[68:71], v[224:227]
  ds_read_b64_tr_b16 v[170:171], v13 offset:256
  v_mfma_f32_16x16x32_bf16 v[228:231], v[184:187], v[64:67], v[228:231]
  ds_read_b64_tr_b16 v[172:173], v13 offset:1024
  s_mov_b32 s50, 360448
  buffer_load_dwordx4 v[248:251], v252, s[24:27], s50 offen offset:0
  v_mfma_f32_16x16x32_bf16 v[232:235], v[184:187], v[68:71], v[232:235]
  ds_read_b64_tr_b16 v[174:175], v13 offset:1280
  v_mfma_f32_16x16x32_bf16 v[236:239], v[188:191], v[64:67], v[236:239]
  ds_read_b64_tr_b16 v[176:177], v13 offset:2048
  v_mfma_f32_16x16x32_bf16 v[240:243], v[188:191], v[68:71], v[240:243]
  ds_read_b64_tr_b16 v[178:179], v13 offset:2304
  s_waitcnt lgkmcnt(6)
  v_mfma_f32_16x16x32_bf16 v[220:223], v[192:195], v[72:75], v[220:223]
  ds_read_b64_tr_b16 v[180:181], v13 offset:6144
  v_mfma_f32_16x16x32_bf16 v[224:227], v[192:195], v[76:79], v[224:227]
  ds_read_b64_tr_b16 v[182:183], v13 offset:6400
  v_mfma_f32_16x16x32_bf16 v[228:231], v[196:199], v[72:75], v[228:231]
  ds_read_b64_tr_b16 v[184:185], v13 offset:7168
  s_mov_b32 s50, 720896
  buffer_load_dwordx4 v[248:251], v252, s[24:27], s50 offen offset:0
  v_mfma_f32_16x16x32_bf16 v[232:235], v[196:199], v[76:79], v[232:235]
  ds_read_b64_tr_b16 v[186:187], v13 offset:7424
  v_mfma_f32_16x16x32_bf16 v[236:239], v[200:203], v[72:75], v[236:239]
  ds_read_b64_tr_b16 v[188:189], v13 offset:8192
  v_mfma_f32_16x16x32_bf16 v[240:243], v[200:203], v[76:79], v[240:243]
  ds_read_b64_tr_b16 v[190:191], v13 offset:8448
  s_waitcnt lgkmcnt(6)
  v_mfma_f32_16x16x32_bf16 v[220:223], v[168:171], v[80:83], v[220:223]
  ds_read_b64_tr_b16 v[192:193], v13 offset:12288
  v_and_b32 v4, 31, v1
  v_lshrrev_b32 v5, 5, v1
  v_mfma_f32_16x16x32_bf16 v[224:227], v[168:171], v[84:87], v[224:227]
  ds_read_b64_tr_b16 v[194:195], v13 offset:12544
  v_lshlrev_b32 v5, 2, v5
  v_sub_u32 v4, v4, v5
  v_mfma_f32_16x16x32_bf16 v[228:231], v[172:175], v[80:83], v[228:231]
  ds_read_b64_tr_b16 v[196:197], v13 offset:13312
  s_mov_b32 s50, 1064960
  buffer_load_dwordx4 v[248:251], v252, s[24:27], s50 offen offset:0
  v_mov_b32 v5, 0xf149f2ca
  v_cmp_le_i32 vcc, 0, v4
  v_mfma_f32_16x16x32_bf16 v[232:235], v[172:175], v[84:87], v[232:235]
  ds_read_b64_tr_b16 v[198:199], v13 offset:13568
  v_mov_b32 v56, s45
  v_cndmask_b32 v144, v5, 0, vcc
  v_mfma_f32_16x16x32_bf16 v[236:239], v[176:179], v[80:83], v[236:239]
  ds_read_b64_tr_b16 v[200:201], v13 offset:14336
  v_cndmask_b32 v204, 0, v5, vcc
  v_cmp_le_i32 vcc, 1, v4
  v_mfma_f32_16x16x32_bf16 v[240:243], v[176:179], v[84:87], v[240:243]
  ds_read_b64_tr_b16 v[202:203], v13 offset:14592
  v_mov_b32 v57, s45
  v_cndmask_b32 v145, v5, 0, vcc
  s_waitcnt lgkmcnt(6)
  v_mfma_f32_16x16x32_bf16 v[220:223], v[180:183], v[88:91], v[220:223]
  ds_read_b64_tr_b16 v[168:169], v13 offset:18432
  v_cndmask_b32 v205, 0, v5, vcc
  v_cmp_le_i32 vcc, 2, v4
  v_mfma_f32_16x16x32_bf16 v[224:227], v[180:183], v[92:95], v[224:227]
  ds_read_b64_tr_b16 v[170:171], v13 offset:18688
  v_mov_b32 v58, s45
  v_cndmask_b32 v146, v5, 0, vcc
  v_mfma_f32_16x16x32_bf16 v[228:231], v[184:187], v[88:91], v[228:231]
  ds_read_b64_tr_b16 v[172:173], v13 offset:19456
  s_mov_b32 s50, 196608
  buffer_load_dwordx4 v[248:251], v253, s[24:27], s50 offen offset:0
  v_cndmask_b32 v206, 0, v5, vcc
  v_cmp_le_i32 vcc, 3, v4
  v_mfma_f32_16x16x32_bf16 v[232:235], v[184:187], v[92:95], v[232:235]
  ds_read_b64_tr_b16 v[174:175], v13 offset:19712
  v_mov_b32 v59, s45
  v_cndmask_b32 v147, v5, 0, vcc
  v_mfma_f32_16x16x32_bf16 v[236:239], v[188:191], v[88:91], v[236:239]
  ds_read_b64_tr_b16 v[176:177], v13 offset:20480
  v_cndmask_b32 v207, 0, v5, vcc
  v_cmp_le_i32 vcc, 8, v4
  v_mfma_f32_16x16x32_bf16 v[240:243], v[188:191], v[92:95], v[240:243]
  ds_read_b64_tr_b16 v[178:179], v13 offset:20736
  v_mov_b32 v60, s45
  v_cndmask_b32 v148, v5, 0, vcc
  s_waitcnt vmcnt(5)
  s_barrier
  s_waitcnt lgkmcnt(6)
  v_mfma_f32_16x16x32_bf16 v[220:223], v[192:195], v[96:99], v[220:223]
  ds_read_b64_tr_b16 v[180:181], v13 offset:24576
  v_cndmask_b32 v208, 0, v5, vcc
  v_cmp_le_i32 vcc, 9, v4
  v_mfma_f32_16x16x32_bf16 v[224:227], v[192:195], v[100:103], v[224:227]
  ds_read_b64_tr_b16 v[182:183], v13 offset:24832
  v_mov_b32 v61, s45
  v_cndmask_b32 v149, v5, 0, vcc
  v_mfma_f32_16x16x32_bf16 v[228:231], v[196:199], v[96:99], v[228:231]
  ds_read_b64_tr_b16 v[184:185], v13 offset:25600
  s_mov_b32 s50, 557056
  buffer_load_dwordx4 v[248:251], v253, s[24:27], s50 offen offset:0
  v_cndmask_b32 v209, 0, v5, vcc
  v_cmp_le_i32 vcc, 10, v4
  v_mfma_f32_16x16x32_bf16 v[232:235], v[196:199], v[100:103], v[232:235]
  ds_read_b64_tr_b16 v[186:187], v13 offset:25856
  v_mov_b32 v62, s45
  v_cndmask_b32 v150, v5, 0, vcc
  v_mfma_f32_16x16x32_bf16 v[236:239], v[200:203], v[96:99], v[236:239]
  ds_read_b64_tr_b16 v[188:189], v13 offset:26624
  v_cndmask_b32 v210, 0, v5, vcc
  v_cmp_le_i32 vcc, 11, v4
  v_mfma_f32_16x16x32_bf16 v[240:243], v[200:203], v[100:103], v[240:243]
  ds_read_b64_tr_b16 v[190:191], v13 offset:26880
  v_mov_b32 v63, s45
  v_cndmask_b32 v151, v5, 0, vcc
  s_waitcnt lgkmcnt(6)
  v_mfma_f32_16x16x32_bf16 v[220:223], v[168:171], v[104:107], v[220:223]
  ds_read_b64_tr_b16 v[192:193], v13 offset:30720
  v_cndmask_b32 v211, 0, v5, vcc
  v_cmp_le_i32 vcc, 16, v4
  v_mfma_f32_16x16x32_bf16 v[224:227], v[168:171], v[108:111], v[224:227]
  ds_read_b64_tr_b16 v[194:195], v13 offset:30976
  v_mov_b32 v64, s45
  v_cndmask_b32 v152, v5, 0, vcc
  v_mfma_f32_16x16x32_bf16 v[228:231], v[172:175], v[104:107], v[228:231]
  ds_read_b64_tr_b16 v[196:197], v13 offset:31744
  s_mov_b32 s50, 917504
  buffer_load_dwordx4 v[248:251], v253, s[24:27], s50 offen offset:0
  v_cndmask_b32 v212, 0, v5, vcc
  v_cmp_le_i32 vcc, 17, v4
  v_mfma_f32_16x16x32_bf16 v[232:235], v[172:175], v[108:111], v[232:235]
  ds_read_b64_tr_b16 v[198:199], v13 offset:32000
  v_mov_b32 v65, s45
  v_cndmask_b32 v153, v5, 0, vcc
  v_mfma_f32_16x16x32_bf16 v[236:239], v[176:179], v[104:107], v[236:239]
  ds_read_b64_tr_b16 v[200:201], v13 offset:32768
  v_cndmask_b32 v213, 0, v5, vcc
  v_cmp_le_i32 vcc, 18, v4
  v_mfma_f32_16x16x32_bf16 v[240:243], v[176:179], v[108:111], v[240:243]
  ds_read_b64_tr_b16 v[202:203], v13 offset:33024
  v_mov_b32 v66, s45
  v_cndmask_b32 v154, v5, 0, vcc
  s_waitcnt lgkmcnt(6)
  v_mfma_f32_16x16x32_bf16 v[220:223], v[180:183], v[112:115], v[220:223]
  ds_read_b64_tr_b16 v[168:169], v13 offset:36864
  v_cndmask_b32 v214, 0, v5, vcc
  v_cmp_le_i32 vcc, 19, v4
  v_mfma_f32_16x16x32_bf16 v[224:227], v[180:183], v[116:119], v[224:227]
  ds_read_b64_tr_b16 v[170:171], v13 offset:37120
  v_mov_b32 v67, s45
  v_cndmask_b32 v155, v5, 0, vcc
  v_mfma_f32_16x16x32_bf16 v[228:231], v[184:187], v[112:115], v[228:231]
  ds_read_b64_tr_b16 v[172:173], v13 offset:37888
  v_cndmask_b32 v215, 0, v5, vcc
  v_cmp_le_i32 vcc, 24, v4
  v_mfma_f32_16x16x32_bf16 v[232:235], v[184:187], v[116:119], v[232:235]
  ds_read_b64_tr_b16 v[174:175], v13 offset:38144
  v_mov_b32 v68, s45
  v_cndmask_b32 v156, v5, 0, vcc
  v_mfma_f32_16x16x32_bf16 v[236:239], v[188:191], v[112:115], v[236:239]
  ds_read_b64_tr_b16 v[176:177], v13 offset:38912
  v_cndmask_b32 v216, 0, v5, vcc
  v_cmp_le_i32 vcc, 25, v4
  v_mfma_f32_16x16x32_bf16 v[240:243], v[188:191], v[116:119], v[240:243]
  ds_read_b64_tr_b16 v[178:179], v13 offset:39168
  v_mov_b32 v69, s45
  v_cndmask_b32 v157, v5, 0, vcc
  s_waitcnt lgkmcnt(6)
  v_mfma_f32_16x16x32_bf16 v[220:223], v[192:195], v[120:123], v[220:223]
  ds_read_b64_tr_b16 v[180:181], v13 offset:43008
  v_cndmask_b32 v217, 0, v5, vcc
  v_cmp_le_i32 vcc, 26, v4
  v_mfma_f32_16x16x32_bf16 v[224:227], v[192:195], v[124:127], v[224:227]
  ds_read_b64_tr_b16 v[182:183], v13 offset:43264
  v_mov_b32 v70, s45
  v_cndmask_b32 v158, v5, 0, vcc
  v_mfma_f32_16x16x32_bf16 v[228:231], v[196:199], v[120:123], v[228:231]
  ds_read_b64_tr_b16 v[184:185], v13 offset:44032
  v_cndmask_b32 v218, 0, v5, vcc
  v_cmp_le_i32 vcc, 27, v4
  v_mfma_f32_16x16x32_bf16 v[232:235], v[196:199], v[124:127], v[232:235]
  ds_read_b64_tr_b16 v[186:187], v13 offset:44288
  v_mov_b32 v71, s45
  v_cndmask_b32 v159, v5, 0, vcc
  v_mfma_f32_16x16x32_bf16 v[236:239], v[200:203], v[120:123], v[236:239]
  ds_read_b64_tr_b16 v[188:189], v13 offset:45056
  v_cndmask_b32 v219, 0, v5, vcc
  v_mfma_f32_16x16x32_bf16 v[240:243], v[200:203], v[124:127], v[240:243]
  ds_read_b64_tr_b16 v[190:191], v13 offset:45312
  s_waitcnt lgkmcnt(6)
  v_mfma_f32_16x16x32_bf16 v[220:223], v[168:171], v[128:131], v[220:223]
  v_mfma_f32_16x16x32_bf16 v[224:227], v[168:171], v[132:135], v[224:227]
  v_mfma_f32_16x16x32_bf16 v[228:231], v[172:175], v[128:131], v[228:231]
  v_mfma_f32_16x16x32_bf16 v[232:235], v[172:175], v[132:135], v[232:235]
  v_mfma_f32_16x16x32_bf16 v[236:239], v[176:179], v[128:131], v[236:239]
  v_mfma_f32_16x16x32_bf16 v[240:243], v[176:179], v[132:135], v[240:243]
  s_waitcnt lgkmcnt(0)
  s_lshl_b32 s47, s40, 4
  s_sub_u32 s47, s47, 32
  v_min_u32 v6, 47, v1
  v_add_u32 v6, s47, v6
  v_max_i32 v6, 0, v6
  v_lshlrev_b32 v6, 3, v6
  s_mov_b32 s50, 14684160
  buffer_load_dwordx2 v[244:245], v6, s[36:39], s50 offen sc1
  v_mfma_f32_16x16x32_bf16 v[220:223], v[180:183], v[136:139], v[220:223]
  v_mfma_f32_16x16x32_bf16 v[224:227], v[180:183], v[140:143], v[224:227]
  v_mfma_f32_16x16x32_bf16 v[228:231], v[184:187], v[136:139], v[228:231]
  v_mfma_f32_16x16x32_bf16 v[232:235], v[184:187], v[140:143], v[232:235]
  v_mfma_f32_16x16x32_bf16 v[236:239], v[188:191], v[136:139], v[236:239]
  v_mfma_f32_16x16x32_bf16 v[240:243], v[188:191], v[140:143], v[240:243]
  s_mul_i32 s98, s46, 86
  s_lshr_b32 s48, s100, 5
  s_add_u32 s98, s98, s48
  s_add_u32 s98, s98, s44
  s_lshl_b32 s98, s98, 10
  s_add_u32 s98, s98, 8388608
  s_mov_b32 s4, 0xbfb8aa3b
  s_mov_b32 s5, 0xbfb8aa3b
  s_waitcnt vmcnt(0)
  v_cmp_ne_u64 vcc, s[6:7], v[244:245]
  s_nop 3
  s_cbranch_vccz L_q1
  s_mov_b32 s58, 0
  s_mov_b32 s50, 14684160
L_p1:
  buffer_load_dwordx2 v[244:245], v6, s[36:39], s50 offen offset:0 sc1
  s_waitcnt vmcnt(0)
  v_cmp_ne_u64 vcc, s[6:7], v[244:245]
  s_nop 3
  s_cbranch_vccnz L_r1
  s_branch L_q1
L_r1:
  s_sleep 1
  s_add_u32 s58, s58, 1
  s_cmp_lt_u32 s58, 0x40000
  s_cbranch_scc1 L_p1
L_q1:
  s_lshl_b32 s48, s41, 1
  s_add_u32 s48, s48, s44
  s_lshl_b32 s48, s48, 10
  s_lshl_b32 s47, s46, 15
  s_add_u32 s50, s47, s48
  buffer_load_dwordx4 v[52:55], v14, s[36:39], s50 offen sc1
  s_lshl_b32 s49, s44, 10
  s_lshl_b32 s47, s41, 11
  s_add_u32 s48, s49, s47
  s_lshl_b32 s47, s43, 11
  s_add_u32 s49, s49, s47
  s_add_u32 s48, s48, 2097152
  s_sub_i32 s50, s46, 0
  s_max_i32 s50, s50, 0
  s_lshl_b32 s50, s50, 15
  s_add_u32 s50, s50, s48
  s_add_u32 m0, s49, 65536
  s_nop 0
  buffer_load_dwordx4 v14, s[36:39], s50 offen sc1 lds
  s_sub_i32 s50, s46, 4
  s_max_i32 s50, s50, 0
  s_lshl_b32 s50, s50, 15
  s_add_u32 s50, s50, s48
  s_add_u32 m0, s49, 57344
  s_nop 0
  buffer_load_dwordx4 v14, s[36:39], s50 offen sc1 lds
  s_sub_i32 s50, s46, 8
  s_max_i32 s50, s50, 0
  s_lshl_b32 s50, s50, 15
  s_add_u32 s50, s50, s48
  s_add_u32 m0, s49, 49152
  s_nop 0
  buffer_load_dwordx4 v14, s[36:39], s50 offen sc1 lds
  s_add_u32 s48, s48, 2097152
  s_sub_i32 s50, s46, 0
  s_max_i32 s50, s50, 0
  s_lshl_b32 s50, s50, 15
  s_add_u32 s50, s50, s48
  s_add_u32 m0, s49, 90112
  s_nop 0
  buffer_load_dwordx4 v14, s[36:39], s50 offen sc1 lds
  s_sub_i32 s50, s46, 4
  s_max_i32 s50, s50, 0
  s_lshl_b32 s50, s50, 15
  s_add_u32 s50, s50, s48
  s_add_u32 m0, s49, 81920
  s_nop 0
  buffer_load_dwordx4 v14, s[36:39], s50 offen sc1 lds
  s_sub_i32 s50, s46, 8
  s_max_i32 s50, s50, 0
  s_lshl_b32 s50, s50, 15
  s_add_u32 s50, s50, s48
  s_add_u32 m0, s49, 73728
  s_nop 0
  buffer_load_dwordx4 v14, s[36:39], s50 offen sc1 lds
  v_pk_mul_f32 v[180:181], v[220:221], s[4:5]
  v_pk_mul_f32 v[182:183], v[222:223], s[4:5]
  v_pk_mul_f32 v[184:185], v[224:225], s[4:5]
  v_pk_mul_f32 v[186:187], v[226:227], s[4:5]
  v_exp_f32 v180, v180
  v_exp_f32 v181, v181
  v_exp_f32 v182, v182
  v_exp_f32 v183, v183
  v_exp_f32 v184, v184
  v_exp_f32 v185, v185
  v_exp_f32 v186, v186
  v_exp_f32 v187, v187
  v_pk_add_f32 v[180:181], v[180:181], 1.0 op_sel_hi:[1,0]
  v_pk_add_f32 v[182:183], v[182:183], 1.0 op_sel_hi:[1,0]
  v_pk_add_f32 v[184:185], v[184:185], 1.0 op_sel_hi:[1,0]
  v_pk_add_f32 v[186:187], v[186:187], 1.0 op_sel_hi:[1,0]
  v_rcp_f32 v180, v180
  v_rcp_f32 v181, v181
  v_rcp_f32 v182, v182
  v_rcp_f32 v183, v183
  v_rcp_f32 v184, v184
  v_rcp_f32 v185, v185
  v_rcp_f32 v186, v186
  v_rcp_f32 v187, v187
  v_pk_mul_f32 v[220:221], v[220:221], v[180:181]
  v_pk_mul_f32 v[222:223], v[222:223], v[182:183]
  v_pk_mul_f32 v[224:225], v[224:225], v[184:185]
  v_pk_mul_f32 v[226:227], v[226:227], v[186:187]
  v_cvt_pk_bf16_f32 v168, v220, v221
  v_cvt_pk_bf16_f32 v169, v222, v223
  v_cvt_pk_bf16_f32 v170, v224, v225
  v_cvt_pk_bf16_f32 v171, v226, v227
  s_nop 0
  v_permlane32_swap_b32 v168, v170
  v_permlane32_swap_b32 v169, v171
  buffer_store_dwordx4 v[168:171], v15, s[36:39], s98 offen offset:0 sc1
  v_pk_mul_f32 v[180:181], v[228:229], s[4:5]
  v_pk_mul_f32 v[182:183], v[230:231], s[4:5]
  v_pk_mul_f32 v[184:185], v[232:233], s[4:5]
  v_pk_mul_f32 v[186:187], v[234:235], s[4:5]
  v_exp_f32 v180, v180
  v_exp_f32 v181, v181
  v_exp_f32 v182, v182
  v_exp_f32 v183, v183
  v_exp_f32 v184, v184
  v_exp_f32 v185, v185
  v_exp_f32 v186, v186
  v_exp_f32 v187, v187
  v_pk_add_f32 v[180:181], v[180:181], 1.0 op_sel_hi:[1,0]
  v_pk_add_f32 v[182:183], v[182:183], 1.0 op_sel_hi:[1,0]
  v_pk_add_f32 v[184:185], v[184:185], 1.0 op_sel_hi:[1,0]
  v_pk_add_f32 v[186:187], v[186:187], 1.0 op_sel_hi:[1,0]
  v_rcp_f32 v180, v180
  v_rcp_f32 v181, v181
  v_rcp_f32 v182, v182
  v_rcp_f32 v183, v183
  v_rcp_f32 v184, v184
  v_rcp_f32 v185, v185
  v_rcp_f32 v186, v186
  v_rcp_f32 v187, v187
  v_pk_mul_f32 v[228:229], v[228:229], v[180:181]
  v_pk_mul_f32 v[230:231], v[230:231], v[182:183]
  v_pk_mul_f32 v[232:233], v[232:233], v[184:185]
  v_pk_mul_f32 v[234:235], v[234:235], v[186:187]
  v_cvt_pk_bf16_f32 v172, v228, v229
  v_cvt_pk_bf16_f32 v173, v230, v231
  v_cvt_pk_bf16_f32 v174, v232, v233
  v_cvt_pk_bf16_f32 v175, v234, v235
  s_nop 0
  v_permlane32_swap_b32 v172, v174
  v_permlane32_swap_b32 v173, v175
  buffer_store_dwordx4 v[172:175], v15, s[36:39], s98 offen offset:2048 sc1
  v_pk_mul_f32 v[180:181], v[236:237], s[4:5]
  v_pk_mul_f32 v[182:183], v[238:239], s[4:5]
  v_pk_mul_f32 v[184:185], v[240:241], s[4:5]
  v_pk_mul_f32 v[186:187], v[242:243], s[4:5]
  v_exp_f32 v180, v180
  v_exp_f32 v181, v181
  v_exp_f32 v182, v182
  v_exp_f32 v183, v183
  v_exp_f32 v184, v184
  v_exp_f32 v185, v185
  v_exp_f32 v186, v186
  v_exp_f32 v187, v187
  v_pk_add_f32 v[180:181], v[180:181], 1.0 op_sel_hi:[1,0]
  v_pk_add_f32 v[182:183], v[182:183], 1.0 op_sel_hi:[1,0]
  v_pk_add_f32 v[184:185], v[184:185], 1.0 op_sel_hi:[1,0]
  v_pk_add_f32 v[186:187], v[186:187], 1.0 op_sel_hi:[1,0]
  v_rcp_f32 v180, v180
  v_rcp_f32 v181, v181
  v_rcp_f32 v182, v182
  v_rcp_f32 v183, v183
  v_rcp_f32 v184, v184
  v_rcp_f32 v185, v185
  v_rcp_f32 v186, v186
  v_rcp_f32 v187, v187
  v_pk_mul_f32 v[236:237], v[236:237], v[180:181]
  v_pk_mul_f32 v[238:239], v[238:239], v[182:183]
  v_pk_mul_f32 v[240:241], v[240:241], v[184:185]
  v_pk_mul_f32 v[242:243], v[242:243], v[186:187]
  v_cvt_pk_bf16_f32 v176, v236, v237
  v_cvt_pk_bf16_f32 v177, v238, v239
  v_cvt_pk_bf16_f32 v178, v240, v241
  v_cvt_pk_bf16_f32 v179, v242, v243
  s_nop 0
  v_permlane32_swap_b32 v176, v178
  v_permlane32_swap_b32 v177, v179
  s_add_u32 s98, s98, 4096
  buffer_store_dwordx4 v[176:179], v15, s[36:39], s98 offen offset:0 sc1
  v_lshrrev_b32 v3, 2, v1
  v_and_b32 v10, 3, v1
  v_lshlrev_b32 v10, 4, v10
  v_lshl_add_u32 v8, v3, 10, v10
  s_mul_i32 s57, s53, 22
  s_cmp_eq_u32 s53, 3
  s_subb_u32 s57, s57, 0
  s_add_u32 s49, s57, s54
  s_lshl_b32 s49, s49, 14
  s_lshl_b32 s47, s52, 7
  s_add_u32 s49, s49, s47
  s_lshl_b32 s56, s53, 11
  s_lshl_b32 s47, s54, 13
  s_add_u32 s56, s56, s47
  s_lshl_b32 s47, s43, 1
  s_add_u32 s47, s47, s44
  s_lshl_b32 s47, s47, 10
  s_add_u32 s47, s47, 49152
  v_add_u32 v7, s47, v14
  v_lshrrev_b32 v3, 5, v1
  v_and_b32 v10, 15, v1
  v_lshlrev_b32 v10, 4, v10
  v_lshl_add_u32 v10, v3, 8, v10
  s_add_u32 s47, s47, 24576
  v_add_u32 v9, s47, v10
  s_waitcnt vmcnt(6)
  s_barrier
  ds_read_b128 v[16:19], v7 offset:16384
  ds_read_b128 v[20:23], v7 offset:14336
  ds_read_b128 v[24:27], v7 offset:12288
  ds_read_b128 v[28:31], v7 offset:10240
  ds_read_b128 v[32:35], v7 offset:8192
  ds_read_b128 v[36:39], v7 offset:6144
  ds_read_b128 v[40:43], v7 offset:4096
  ds_read_b128 v[44:47], v7 offset:2048
  ds_read_b128 v[48:51], v7 offset:0
  s_waitcnt lgkmcnt(0)
  v_mfma_f32_32x32x16_bf16 v[80:95], v[16:19], v[52:55], v[144:159]
  v_mfma_f32_32x32x16_bf16 v[96:111], v[20:23], v[52:55], 0
  v_mfma_f32_32x32x16_bf16 v[112:127], v[24:27], v[52:55], 0
  s_nop 9
  v_max_f32 v4, v80, v81
  v_max_f32 v5, v82, v83
  v_max3_f32 v4, v84, v85, v4
  v_max3_f32 v5, v86, v87, v5
  v_max3_f32 v4, v88, v89, v4
  v_max3_f32 v5, v90, v91, v5
  v_max3_f32 v4, v92, v93, v4
  v_max3_f32 v5, v94, v95, v5
  s_cmp_eq_u32 s46, 0
  s_cbranch_scc1 L_a1
  v_mfma_f32_32x32x16_bf16 v[80:95], v[28:31], v[52:55], 0
  v_max3_f32 v4, v96, v97, v4
  v_max3_f32 v5, v98, v99, v5
  v_max3_f32 v4, v100, v101, v4
  v_max3_f32 v5, v102, v103, v5
  v_max3_f32 v4, v104, v105, v4
  v_max3_f32 v5, v106, v107, v5
  v_max3_f32 v4, v108, v109, v4
  v_max3_f32 v5, v110, v111, v5
  s_cmp_eq_u32 s46, 1
  s_cbranch_scc1 L_a1
  v_mfma_f32_32x32x16_bf16 v[96:111], v[32:35], v[52:55], 0
  v_max3_f32 v4, v112, v113, v4
  v_max3_f32 v5, v114, v115, v5
  v_max3_f32 v4, v116, v117, v4
  v_max3_f32 v5, v118, v119, v5
  v_max3_f32 v4, v120, v121, v4
  v_max3_f32 v5, v122, v123, v5
  v_max3_f32 v4, v124, v125, v4
  v_max3_f32 v5, v126, v127, v5
  s_cmp_eq_u32 s46, 2
  s_cbranch_scc1 L_a1
  v_mfma_f32_32x32x16_bf16 v[112:127], v[36:39], v[52:55], 0
  v_max3_f32 v4, v80, v81, v4
  v_max3_f32 v5, v82, v83, v5
  v_max3_f32 v4, v84, v85, v4
  v_max3_f32 v5, v86, v87, v5
  v_max3_f32 v4, v88, v89, v4
  v_max3_f32 v5, v90, v91, v5
  v_max3_f32 v4, v92, v93, v4
  v_max3_f32 v5, v94, v95, v5
  s_cmp_eq_u32 s46, 3
  s_cbranch_scc1 L_a1
  v_mfma_f32_32x32x16_bf16 v[80:95], v[40:43], v[52:55], 0
  v_max3_f32 v4, v96, v97, v4
  v_max3_f32 v5, v98, v99, v5
  v_max3_f32 v4, v100, v101, v4
  v_max3_f32 v5, v102, v103, v5
  v_max3_f32 v4, v104, v105, v4
  v_max3_f32 v5, v106, v107, v5
  v_max3_f32 v4, v108, v109, v4
  v_max3_f32 v5, v110, v111, v5
  s_cmp_eq_u32 s46, 4
  s_cbranch_scc1 L_a1
  v_mfma_f32_32x32x16_bf16 v[96:111], v[44:47], v[52:55], 0
  v_max3_f32 v4, v112, v113, v4
  v_max3_f32 v5, v114, v115, v5
  v_max3_f32 v4, v116, v117, v4
  v_max3_f32 v5, v118, v119, v5
  v_max3_f32 v4, v120, v121, v4
  v_max3_f32 v5, v122, v123, v5
  v_max3_f32 v4, v124, v125, v4
  v_max3_f32 v5, v126, v127, v5
  s_cmp_eq_u32 s46, 5
  s_cbranch_scc1 L_a1
  v_mfma_f32_32x32x16_bf16 v[112:127], v[48:51], v[52:55], v[204:219]
  v_max3_f32 v4, v80, v81, v4
  v_max3_f32 v5, v82, v83, v5
  v_max3_f32 v4, v84, v85, v4
  v_max3_f32 v5, v86, v87, v5
  v_max3_f32 v4, v88, v89, v4
  v_max3_f32 v5, v90, v91, v5
  v_max3_f32 v4, v92, v93, v4
  v_max3_f32 v5, v94, v95, v5
  s_cmp_eq_u32 s46, 6
  s_cbranch_scc1 L_a1
  v_max3_f32 v4, v96, v97, v4
  v_max3_f32 v5, v98, v99, v5
  v_max3_f32 v4, v100, v101, v4
  v_max3_f32 v5, v102, v103, v5
  v_max3_f32 v4, v104, v105, v4
  v_max3_f32 v5, v106, v107, v5
  v_max3_f32 v4, v108, v109, v4
  v_max3_f32 v5, v110, v111, v5
  s_cmp_eq_u32 s46, 7
  s_cbranch_scc1 L_a1
  v_max3_f32 v4, v112, v113, v4
  v_max3_f32 v5, v114, v115, v5
  v_max3_f32 v4, v116, v117, v4
  v_max3_f32 v5, v118, v119, v5
  v_max3_f32 v4, v120, v121, v4
  v_max3_f32 v5, v122, v123, v5
  v_max3_f32 v4, v124, v125, v4
  v_max3_f32 v5, v126, v127, v5
L_a1:
  v_max_f32 v4, v4, v5
  v_mov_b32 v5, v4
  s_nop 1
  v_permlane32_swap_b32 v4, v5
  v_max_f32 v4, v4, v5
  s_nop 7
  v_sub_f32 v144, v144, v4
  v_sub_f32 v145, v145, v4
  v_sub_f32 v146, v146, v4
  v_sub_f32 v147, v147, v4
  v_sub_f32 v148, v148, v4
  v_sub_f32 v149, v149, v4
  v_sub_f32 v150, v150, v4
  v_sub_f32 v151, v151, v4
  v_sub_f32 v152, v152, v4
  v_sub_f32 v153, v153, v4
  v_sub_f32 v154, v154, v4
  v_sub_f32 v155, v155, v4
  v_sub_f32 v156, v156, v4
  v_sub_f32 v157, v157, v4
  v_sub_f32 v158, v158, v4
  v_sub_f32 v159, v159, v4
  v_sub_f32 v128, 0, v4
  v_sub_f32 v129, 0, v4
  v_sub_f32 v130, 0, v4
  v_sub_f32 v131, 0, v4
  v_sub_f32 v132, 0, v4
  v_sub_f32 v133, 0, v4
  v_sub_f32 v134, 0, v4
  v_sub_f32 v135, 0, v4
  v_sub_f32 v136, 0, v4
  v_sub_f32 v137, 0, v4
  v_sub_f32 v138, 0, v4
  v_sub_f32 v139, 0, v4
  v_sub_f32 v140, 0, v4
  v_sub_f32 v141, 0, v4
  v_sub_f32 v142, 0, v4
  v_sub_f32 v143, 0, v4
  v_sub_f32 v204, v204, v4
  v_sub_f32 v205, v205, v4
  v_sub_f32 v206, v206, v4
  v_sub_f32 v207, v207, v4
  v_sub_f32 v208, v208, v4
  v_sub_f32 v209, v209, v4
  v_sub_f32 v210, v210, v4
  v_sub_f32 v211, v211, v4
  v_sub_f32 v212, v212, v4
  v_sub_f32 v213, v213, v4
  v_sub_f32 v214, v214, v4
  v_sub_f32 v215, v215, v4
  v_sub_f32 v216, v216, v4
  v_sub_f32 v217, v217, v4
  v_sub_f32 v218, v218, v4
  v_sub_f32 v219, v219, v4
  s_waitcnt vmcnt(0)
  s_barrier
  s_cmp_lg_u32 s42, 0
  s_cbranch_scc1 L_f2
  s_mov_b64 exec, 1
  s_lshl_b32 s47, s55, 3
  s_add_u32 s47, s47, 14686208
  v_mov_b32 v4, s6
  v_mov_b32 v5, s7
  v_mov_b32 v3, 0
  buffer_store_dwordx2 v[4:5], v3, s[36:39], s47 offen sc1
  s_mov_b64 exec, -1
L_f2:
  s_lshr_b32 s47, s51, 1
  s_lshl_b32 s47, s47, 7
  v_and_b32 v6, 15, v1
  v_lshlrev_b32 v6, 3, v6
  v_add_u32 v6, s47, v6
  s_mov_b32 s48, 14686208
  s_mov_b32 exec_lo, 0xffff
  s_mov_b32 exec_hi, 0xffff
  ds_read_b128 v[56:59], v9 offset:16384
  ds_read_b128 v[60:63], v9 offset:16896
  s_mov_b64 exec, -1
  s_nop 3
  v_mfma_f32_32x32x16_bf16 v[80:95], v[16:19], v[52:55], v[144:159]
  s_cmp_lg_u32 s46, 0
  s_cbranch_scc1 L_m0
  v_mov_b32 v128, 0xf149f2ca
  v_mov_b32 v204, 0xf149f2ca
  v_mov_b32 v129, 0xf149f2ca
  v_mov_b32 v205, 0xf149f2ca
  v_mov_b32 v130, 0xf149f2ca
  v_mov_b32 v206, 0xf149f2ca
  v_mov_b32 v131, 0xf149f2ca
  v_mov_b32 v207, 0xf149f2ca
  v_mov_b32 v132, 0xf149f2ca
  v_mov_b32 v208, 0xf149f2ca
  v_mov_b32 v133, 0xf149f2ca
  v_mov_b32 v209, 0xf149f2ca
  v_mov_b32 v134, 0xf149f2ca
  v_mov_b32 v210, 0xf149f2ca
  v_mov_b32 v135, 0xf149f2ca
  v_mov_b32 v211, 0xf149f2ca
  v_mov_b32 v136, 0xf149f2ca
  v_mov_b32 v212, 0xf149f2ca
  v_mov_b32 v137, 0xf149f2ca
  v_mov_b32 v213, 0xf149f2ca
  v_mov_b32 v138, 0xf149f2ca
  v_mov_b32 v214, 0xf149f2ca
  v_mov_b32 v139, 0xf149f2ca
  v_mov_b32 v215, 0xf149f2ca
  v_mov_b32 v140, 0xf149f2ca
  v_mov_b32 v216, 0xf149f2ca
  v_mov_b32 v141, 0xf149f2ca
  v_mov_b32 v217, 0xf149f2ca
  v_mov_b32 v142, 0xf149f2ca
  v_mov_b32 v218, 0xf149f2ca
  v_mov_b32 v143, 0xf149f2ca
  v_mov_b32 v219, 0xf149f2ca
L_m0:
  s_nop 0
  v_mfma_f32_32x32x16_bf16 v[96:111], v[20:23], v[52:55], v[128:143]
  s_mov_b32 exec_lo, 0xffff
  s_mov_b32 exec_hi, 0xffff
  ds_read_b128 v[64:67], v9 offset:14336
  ds_read_b128 v[68:71], v9 offset:14848
  s_mov_b64 exec, -1
  s_add_u32 m0, s56, 98304
  s_nop 0
  buffer_load_dwordx4 v8, s[24:27], s49 offen offset:0 lds
  s_add_u32 m0, s56, 99264
  s_nop 0
  buffer_load_dwordx4 v8, s[24:27], s49 offen offset:64 lds
  s_add_u32 s49, s49, 32768
  s_mov_b32 s50, 1245184
  buffer_load_dwordx4 v[248:251], v253, s[24:27], s50 offen offset:0
  v_exp_f32 v80, v80
  v_exp_f32 v81, v81
  v_exp_f32 v82, v82
  v_exp_f32 v83, v83
  v_exp_f32 v84, v84
  v_exp_f32 v85, v85
  v_exp_f32 v86, v86
  v_exp_f32 v87, v87
  v_cvt_pk_bf16_f32 v224, v80, v81
  v_cvt_pk_bf16_f32 v225, v82, v83
  v_cvt_pk_bf16_f32 v226, v84, v85
  v_cvt_pk_bf16_f32 v227, v86, v87
  v_exp_f32 v88, v88
  v_exp_f32 v89, v89
  v_exp_f32 v90, v90
  v_exp_f32 v91, v91
  v_exp_f32 v92, v92
  v_exp_f32 v93, v93
  v_exp_f32 v94, v94
  v_exp_f32 v95, v95
  v_cvt_pk_bf16_f32 v228, v88, v89
  v_cvt_pk_bf16_f32 v229, v90, v91
  v_cvt_pk_bf16_f32 v230, v92, v93
  v_cvt_pk_bf16_f32 v231, v94, v95
  s_waitcnt lgkmcnt(2)
  v_mfma_f32_32x32x16_bf16 v[160:175], v[56:59], v[224:227], 0
  v_mfma_f32_32x32x16_bf16 v[160:175], v[60:63], v[228:231], v[160:175]
  s_cmp_lg_u32 s46, 1
  s_cbranch_scc1 L_m1
  v_mov_b32 v128, 0xf149f2ca
  v_mov_b32 v204, 0xf149f2ca
  v_mov_b32 v129, 0xf149f2ca
  v_mov_b32 v205, 0xf149f2ca
  v_mov_b32 v130, 0xf149f2ca
  v_mov_b32 v206, 0xf149f2ca
  v_mov_b32 v131, 0xf149f2ca
  v_mov_b32 v207, 0xf149f2ca
  v_mov_b32 v132, 0xf149f2ca
  v_mov_b32 v208, 0xf149f2ca
  v_mov_b32 v133, 0xf149f2ca
  v_mov_b32 v209, 0xf149f2ca
  v_mov_b32 v134, 0xf149f2ca
  v_mov_b32 v210, 0xf149f2ca
  v_mov_b32 v135, 0xf149f2ca
  v_mov_b32 v211, 0xf149f2ca
  v_mov_b32 v136, 0xf149f2ca
  v_mov_b32 v212, 0xf149f2ca
  v_mov_b32 v137, 0xf149f2ca
  v_mov_b32 v213, 0xf149f2ca
  v_mov_b32 v138, 0xf149f2ca
  v_mov_b32 v214, 0xf149f2ca
  v_mov_b32 v139, 0xf149f2ca
  v_mov_b32 v215, 0xf149f2ca
  v_mov_b32 v140, 0xf149f2ca
  v_mov_b32 v216, 0xf149f2ca
  v_mov_b32 v141, 0xf149f2ca
  v_mov_b32 v217, 0xf149f2ca
  v_mov_b32 v142, 0xf149f2ca
  v_mov_b32 v218, 0xf149f2ca
  v_mov_b32 v143, 0xf149f2ca
  v_mov_b32 v219, 0xf149f2ca
L_m1:
  s_nop 0
  v_mfma_f32_32x32x16_bf16 v[112:127], v[24:27], v[52:55], v[128:143]
  s_mov_b32 exec_lo, 0xffff
  s_mov_b32 exec_hi, 0xffff
  ds_read_b128 v[56:59], v9 offset:12288
  ds_read_b128 v[60:63], v9 offset:12800
  s_mov_b64 exec, -1
  s_add_u32 m0, s56, 114688
  s_nop 0
  buffer_load_dwordx4 v8, s[24:27], s49 offen offset:0 lds
  s_add_u32 m0, s56, 115648
  s_nop 0
  buffer_load_dwordx4 v8, s[24:27], s49 offen offset:64 lds
  s_add_u32 s49, s49, 32768
  s_mov_b32 s50, 0
  buffer_load_dwordx4 v[248:251], v254, s[16:19], s50 offen offset:0
  v_exp_f32 v96, v96
  v_exp_f32 v97, v97
  v_exp_f32 v98, v98
  v_exp_f32 v99, v99
  v_exp_f32 v100, v100
  v_exp_f32 v101, v101
  v_exp_f32 v102, v102
  v_exp_f32 v103, v103
  v_cvt_pk_bf16_f32 v232, v96, v97
  v_cvt_pk_bf16_f32 v233, v98, v99
  v_cvt_pk_bf16_f32 v234, v100, v101
  v_cvt_pk_bf16_f32 v235, v102, v103
  v_exp_f32 v104, v104
  v_exp_f32 v105, v105
  v_exp_f32 v106, v106
  v_exp_f32 v107, v107
  v_exp_f32 v108, v108
  v_exp_f32 v109, v109
  v_exp_f32 v110, v110
  v_exp_f32 v111, v111
  v_cvt_pk_bf16_f32 v236, v104, v105
  v_cvt_pk_bf16_f32 v237, v106, v107
  v_cvt_pk_bf16_f32 v238, v108, v109
  v_cvt_pk_bf16_f32 v239, v110, v111
  s_waitcnt lgkmcnt(2)
  v_mfma_f32_32x32x16_bf16 v[160:175], v[64:67], v[232:235], v[160:175]
  v_mfma_f32_32x32x16_bf16 v[160:175], v[68:71], v[236:239], v[160:175]
  s_cmp_lg_u32 s46, 2
  s_cbranch_scc1 L_m2
  v_mov_b32 v128, 0xf149f2ca
  v_mov_b32 v204, 0xf149f2ca
  v_mov_b32 v129, 0xf149f2ca
  v_mov_b32 v205, 0xf149f2ca
  v_mov_b32 v130, 0xf149f2ca
  v_mov_b32 v206, 0xf149f2ca
  v_mov_b32 v131, 0xf149f2ca
  v_mov_b32 v207, 0xf149f2ca
  v_mov_b32 v132, 0xf149f2ca
  v_mov_b32 v208, 0xf149f2ca
  v_mov_b32 v133, 0xf149f2ca
  v_mov_b32 v209, 0xf149f2ca
  v_mov_b32 v134, 0xf149f2ca
  v_mov_b32 v210, 0xf149f2ca
  v_mov_b32 v135, 0xf149f2ca
  v_mov_b32 v211, 0xf149f2ca
  v_mov_b32 v136, 0xf149f2ca
  v_mov_b32 v212, 0xf149f2ca
  v_mov_b32 v137, 0xf149f2ca
  v_mov_b32 v213, 0xf149f2ca
  v_mov_b32 v138, 0xf149f2ca
  v_mov_b32 v214, 0xf149f2ca
  v_mov_b32 v139, 0xf149f2ca
  v_mov_b32 v215, 0xf149f2ca
  v_mov_b32 v140, 0xf149f2ca
  v_mov_b32 v216, 0xf149f2ca
  v_mov_b32 v141, 0xf149f2ca
  v_mov_b32 v217, 0xf149f2ca
  v_mov_b32 v142, 0xf149f2ca
  v_mov_b32 v218, 0xf149f2ca
  v_mov_b32 v143, 0xf149f2ca
  v_mov_b32 v219, 0xf149f2ca
L_m2:
  s_nop 0
  v_mfma_f32_32x32x16_bf16 v[80:95], v[28:31], v[52:55], v[128:143]
  s_mov_b32 exec_lo, 0xffff
  s_mov_b32 exec_hi, 0xffff
  ds_read_b128 v[64:67], v9 offset:10240
  ds_read_b128 v[68:71], v9 offset:10752
  s_mov_b64 exec, -1
  s_add_u32 m0, s56, 131072
  s_nop 0
  buffer_load_dwordx4 v8, s[24:27], s49 offen offset:0 lds
  s_add_u32 m0, s56, 132032
  s_nop 0
  buffer_load_dwordx4 v8, s[24:27], s49 offen offset:64 lds
  s_add_u32 s49, s49, 32768
  s_mov_b32 s50, 0
  buffer_load_dwordx4 v[248:251], v254, s[16:19], s50 offen offset:1024
  v_exp_f32 v112, v112
  v_exp_f32 v113, v113
  v_exp_f32 v114, v114
  v_exp_f32 v115, v115
  v_exp_f32 v116, v116
  v_exp_f32 v117, v117
  v_exp_f32 v118, v118
  v_exp_f32 v119, v119
  v_cvt_pk_bf16_f32 v224, v112, v113
  v_cvt_pk_bf16_f32 v225, v114, v115
  v_cvt_pk_bf16_f32 v226, v116, v117
  v_cvt_pk_bf16_f32 v227, v118, v119
  v_exp_f32 v120, v120
  v_exp_f32 v121, v121
  v_exp_f32 v122, v122
  v_exp_f32 v123, v123
  v_exp_f32 v124, v124
  v_exp_f32 v125, v125
  v_exp_f32 v126, v126
  v_exp_f32 v127, v127
  v_cvt_pk_bf16_f32 v228, v120, v121
  v_cvt_pk_bf16_f32 v229, v122, v123
  v_cvt_pk_bf16_f32 v230, v124, v125
  v_cvt_pk_bf16_f32 v231, v126, v127
  s_waitcnt lgkmcnt(2)
  v_mfma_f32_32x32x16_bf16 v[160:175], v[56:59], v[224:227], v[160:175]
  v_mfma_f32_32x32x16_bf16 v[160:175], v[60:63], v[228:231], v[160:175]
  s_cmp_lg_u32 s46, 3
  s_cbranch_scc1 L_m3
  v_mov_b32 v128, 0xf149f2ca
  v_mov_b32 v204, 0xf149f2ca
  v_mov_b32 v129, 0xf149f2ca
  v_mov_b32 v205, 0xf149f2ca
  v_mov_b32 v130, 0xf149f2ca
  v_mov_b32 v206, 0xf149f2ca
  v_mov_b32 v131, 0xf149f2ca
  v_mov_b32 v207, 0xf149f2ca
  v_mov_b32 v132, 0xf149f2ca
  v_mov_b32 v208, 0xf149f2ca
  v_mov_b32 v133, 0xf149f2ca
  v_mov_b32 v209, 0xf149f2ca
  v_mov_b32 v134, 0xf149f2ca
  v_mov_b32 v210, 0xf149f2ca
  v_mov_b32 v135, 0xf149f2ca
  v_mov_b32 v211, 0xf149f2ca
  v_mov_b32 v136, 0xf149f2ca
  v_mov_b32 v212, 0xf149f2ca
  v_mov_b32 v137, 0xf149f2ca
  v_mov_b32 v213, 0xf149f2ca
  v_mov_b32 v138, 0xf149f2ca
  v_mov_b32 v214, 0xf149f2ca
  v_mov_b32 v139, 0xf149f2ca
  v_mov_b32 v215, 0xf149f2ca
  v_mov_b32 v140, 0xf149f2ca
  v_mov_b32 v216, 0xf149f2ca
  v_mov_b32 v141, 0xf149f2ca
  v_mov_b32 v217, 0xf149f2ca
  v_mov_b32 v142, 0xf149f2ca
  v_mov_b32 v218, 0xf149f2ca
  v_mov_b32 v143, 0xf149f2ca
  v_mov_b32 v219, 0xf149f2ca
L_m3:
  s_nop 0
  v_mfma_f32_32x32x16_bf16 v[96:111], v[32:35], v[52:55], v[128:143]
  s_mov_b32 exec_lo, 0xffff
  s_mov_b32 exec_hi, 0xffff
  ds_read_b128 v[56:59], v9 offset:8192
  ds_read_b128 v[60:63], v9 offset:8704
  s_mov_b64 exec, -1
  s_add_u32 m0, s56, 0
  s_nop 0
  buffer_load_dwordx4 v8, s[24:27], s49 offen offset:0 lds
  s_add_u32 m0, s56, 960
  s_nop 0
  buffer_load_dwordx4 v8, s[24:27], s49 offen offset:64 lds
  s_add_u32 s49, s49, 32768
  v_exp_f32 v80, v80
  v_exp_f32 v81, v81
  v_exp_f32 v82, v82
  v_exp_f32 v83, v83
  v_exp_f32 v84, v84
  v_exp_f32 v85, v85
  v_exp_f32 v86, v86
  v_exp_f32 v87, v87
  v_cvt_pk_bf16_f32 v232, v80, v81
  v_cvt_pk_bf16_f32 v233, v82, v83
  v_cvt_pk_bf16_f32 v234, v84, v85
  v_cvt_pk_bf16_f32 v235, v86, v87
  v_exp_f32 v88, v88
  v_exp_f32 v89, v89
  v_exp_f32 v90, v90
  v_exp_f32 v91, v91
  v_exp_f32 v92, v92
  v_exp_f32 v93, v93
  v_exp_f32 v94, v94
  v_exp_f32 v95, v95
  v_cvt_pk_bf16_f32 v236, v88, v89
  v_cvt_pk_bf16_f32 v237, v90, v91
  v_cvt_pk_bf16_f32 v238, v92, v93
  v_cvt_pk_bf16_f32 v239, v94, v95
  s_waitcnt lgkmcnt(2)
  v_mfma_f32_32x32x16_bf16 v[160:175], v[64:67], v[232:235], v[160:175]
  v_mfma_f32_32x32x16_bf16 v[160:175], v[68:71], v[236:239], v[160:175]
  s_cmp_lg_u32 s46, 4
  s_cbranch_scc1 L_m4
  v_mov_b32 v128, 0xf149f2ca
  v_mov_b32 v204, 0xf149f2ca
  v_mov_b32 v129, 0xf149f2ca
  v_mov_b32 v205, 0xf149f2ca
  v_mov_b32 v130, 0xf149f2ca
  v_mov_b32 v206, 0xf149f2ca
  v_mov_b32 v131, 0xf149f2ca
  v_mov_b32 v207, 0xf149f2ca
  v_mov_b32 v132, 0xf149f2ca
  v_mov_b32 v208, 0xf149f2ca
  v_mov_b32 v133, 0xf149f2ca
  v_mov_b32 v209, 0xf149f2ca
  v_mov_b32 v134, 0xf149f2ca
  v_mov_b32 v210, 0xf149f2ca
  v_mov_b32 v135, 0xf149f2ca
  v_mov_b32 v211, 0xf149f2ca
  v_mov_b32 v136, 0xf149f2ca
  v_mov_b32 v212, 0xf149f2ca
  v_mov_b32 v137, 0xf149f2ca
  v_mov_b32 v213, 0xf149f2ca
  v_mov_b32 v138, 0xf149f2ca
  v_mov_b32 v214, 0xf149f2ca
  v_mov_b32 v139, 0xf149f2ca
  v_mov_b32 v215, 0xf149f2ca
  v_mov_b32 v140, 0xf149f2ca
  v_mov_b32 v216, 0xf149f2ca
  v_mov_b32 v141, 0xf149f2ca
  v_mov_b32 v217, 0xf149f2ca
  v_mov_b32 v142, 0xf149f2ca
  v_mov_b32 v218, 0xf149f2ca
  v_mov_b32 v143, 0xf149f2ca
  v_mov_b32 v219, 0xf149f2ca
L_m4:
  s_nop 0
  v_mfma_f32_32x32x16_bf16 v[112:127], v[36:39], v[52:55], v[128:143]
  s_mov_b32 exec_lo, 0xffff
  s_mov_b32 exec_hi, 0xffff
  ds_read_b128 v[64:67], v9 offset:6144
  ds_read_b128 v[68:71], v9 offset:6656
  s_mov_b64 exec, -1
  s_add_u32 m0, s56, 16384
  s_nop 0
  buffer_load_dwordx4 v8, s[24:27], s49 offen offset:0 lds
  s_add_u32 m0, s56, 17344
  s_nop 0
  buffer_load_dwordx4 v8, s[24:27], s49 offen offset:64 lds
  s_add_u32 s49, s49, 32768
  v_exp_f32 v96, v96
  v_exp_f32 v97, v97
  v_exp_f32 v98, v98
  v_exp_f32 v99, v99
  v_exp_f32 v100, v100
  v_exp_f32 v101, v101
  v_exp_f32 v102, v102
  v_exp_f32 v103, v103
  v_cvt_pk_bf16_f32 v224, v96, v97
  v_cvt_pk_bf16_f32 v225, v98, v99
  v_cvt_pk_bf16_f32 v226, v100, v101
  v_cvt_pk_bf16_f32 v227, v102, v103
  v_exp_f32 v104, v104
  v_exp_f32 v105, v105
  v_exp_f32 v106, v106
  v_exp_f32 v107, v107
  v_exp_f32 v108, v108
  v_exp_f32 v109, v109
  v_exp_f32 v110, v110
  v_exp_f32 v111, v111
  v_cvt_pk_bf16_f32 v228, v104, v105
  v_cvt_pk_bf16_f32 v229, v106, v107
  v_cvt_pk_bf16_f32 v230, v108, v109
  v_cvt_pk_bf16_f32 v231, v110, v111
  s_waitcnt lgkmcnt(2)
  v_mfma_f32_32x32x16_bf16 v[160:175], v[56:59], v[224:227], v[160:175]
  v_mfma_f32_32x32x16_bf16 v[160:175], v[60:63], v[228:231], v[160:175]
  s_cmp_lg_u32 s46, 5
  s_cbranch_scc1 L_m5
  v_mov_b32 v128, 0xf149f2ca
  v_mov_b32 v204, 0xf149f2ca
  v_mov_b32 v129, 0xf149f2ca
  v_mov_b32 v205, 0xf149f2ca
  v_mov_b32 v130, 0xf149f2ca
  v_mov_b32 v206, 0xf149f2ca
  v_mov_b32 v131, 0xf149f2ca
  v_mov_b32 v207, 0xf149f2ca
  v_mov_b32 v132, 0xf149f2ca
  v_mov_b32 v208, 0xf149f2ca
  v_mov_b32 v133, 0xf149f2ca
  v_mov_b32 v209, 0xf149f2ca
  v_mov_b32 v134, 0xf149f2ca
  v_mov_b32 v210, 0xf149f2ca
  v_mov_b32 v135, 0xf149f2ca
  v_mov_b32 v211, 0xf149f2ca
  v_mov_b32 v136, 0xf149f2ca
  v_mov_b32 v212, 0xf149f2ca
  v_mov_b32 v137, 0xf149f2ca
  v_mov_b32 v213, 0xf149f2ca
  v_mov_b32 v138, 0xf149f2ca
  v_mov_b32 v214, 0xf149f2ca
  v_mov_b32 v139, 0xf149f2ca
  v_mov_b32 v215, 0xf149f2ca
  v_mov_b32 v140, 0xf149f2ca
  v_mov_b32 v216, 0xf149f2ca
  v_mov_b32 v141, 0xf149f2ca
  v_mov_b32 v217, 0xf149f2ca
  v_mov_b32 v142, 0xf149f2ca
  v_mov_b32 v218, 0xf149f2ca
  v_mov_b32 v143, 0xf149f2ca
  v_mov_b32 v219, 0xf149f2ca
L_m5:
  s_nop 0
  v_mfma_f32_32x32x16_bf16 v[80:95], v[40:43], v[52:55], v[128:143]
  s_mov_b32 exec_lo, 0xffff
  s_mov_b32 exec_hi, 0xffff
  ds_read_b128 v[56:59], v9 offset:4096
  ds_read_b128 v[60:63], v9 offset:4608
  s_mov_b64 exec, -1
  s_add_u32 m0, s56, 32768
  s_nop 0
  buffer_load_dwordx4 v8, s[24:27], s49 offen offset:0 lds
  s_add_u32 m0, s56, 33728
  s_nop 0
  buffer_load_dwordx4 v8, s[24:27], s49 offen offset:64 lds
  s_add_u32 s49, s49, 32768
  v_exp_f32 v112, v112
  v_exp_f32 v113, v113
  v_exp_f32 v114, v114
  v_exp_f32 v115, v115
  v_exp_f32 v116, v116
  v_exp_f32 v117, v117
  v_exp_f32 v118, v118
  v_exp_f32 v119, v119
  v_cvt_pk_bf16_f32 v232, v112, v113
  v_cvt_pk_bf16_f32 v233, v114, v115
  v_cvt_pk_bf16_f32 v234, v116, v117
  v_cvt_pk_bf16_f32 v235, v118, v119
  v_exp_f32 v120, v120
  v_exp_f32 v121, v121
  v_exp_f32 v122, v122
  v_exp_f32 v123, v123
  v_exp_f32 v124, v124
  v_exp_f32 v125, v125
  v_exp_f32 v126, v126
  v_exp_f32 v127, v127
  v_cvt_pk_bf16_f32 v236, v120, v121
  v_cvt_pk_bf16_f32 v237, v122, v123
  v_cvt_pk_bf16_f32 v238, v124, v125
  v_cvt_pk_bf16_f32 v239, v126, v127
  s_waitcnt lgkmcnt(2)
  v_mfma_f32_32x32x16_bf16 v[160:175], v[64:67], v[232:235], v[160:175]
  v_mfma_f32_32x32x16_bf16 v[160:175], v[68:71], v[236:239], v[160:175]
  s_cmp_lg_u32 s46, 6
  s_cbranch_scc1 L_m6
  v_mov_b32 v128, 0xf149f2ca
  v_mov_b32 v204, 0xf149f2ca
  v_mov_b32 v129, 0xf149f2ca
  v_mov_b32 v205, 0xf149f2ca
  v_mov_b32 v130, 0xf149f2ca
  v_mov_b32 v206, 0xf149f2ca
  v_mov_b32 v131, 0xf149f2ca
  v_mov_b32 v207, 0xf149f2ca
  v_mov_b32 v132, 0xf149f2ca
  v_mov_b32 v208, 0xf149f2ca
  v_mov_b32 v133, 0xf149f2ca
  v_mov_b32 v209, 0xf149f2ca
  v_mov_b32 v134, 0xf149f2ca
  v_mov_b32 v210, 0xf149f2ca
  v_mov_b32 v135, 0xf149f2ca
  v_mov_b32 v211, 0xf149f2ca
  v_mov_b32 v136, 0xf149f2ca
  v_mov_b32 v212, 0xf149f2ca
  v_mov_b32 v137, 0xf149f2ca
  v_mov_b32 v213, 0xf149f2ca
  v_mov_b32 v138, 0xf149f2ca
  v_mov_b32 v214, 0xf149f2ca
  v_mov_b32 v139, 0xf149f2ca
  v_mov_b32 v215, 0xf149f2ca
  v_mov_b32 v140, 0xf149f2ca
  v_mov_b32 v216, 0xf149f2ca
  v_mov_b32 v141, 0xf149f2ca
  v_mov_b32 v217, 0xf149f2ca
  v_mov_b32 v142, 0xf149f2ca
  v_mov_b32 v218, 0xf149f2ca
  v_mov_b32 v143, 0xf149f2ca
  v_mov_b32 v219, 0xf149f2ca
L_m6:
  s_nop 0
  v_mfma_f32_32x32x16_bf16 v[96:111], v[44:47], v[52:55], v[128:143]
  s_mov_b32 exec_lo, 0xffff
  s_mov_b32 exec_hi, 0xffff
  ds_read_b128 v[64:67], v9 offset:2048
  ds_read_b128 v[68:71], v9 offset:2560
  s_mov_b64 exec, -1
  v_exp_f32 v80, v80
  v_exp_f32 v81, v81
  v_exp_f32 v82, v82
  v_exp_f32 v83, v83
  v_exp_f32 v84, v84
  v_exp_f32 v85, v85
  v_exp_f32 v86, v86
  v_exp_f32 v87, v87
  v_cvt_pk_bf16_f32 v224, v80, v81
  v_cvt_pk_bf16_f32 v225, v82, v83
  v_cvt_pk_bf16_f32 v226, v84, v85
  v_cvt_pk_bf16_f32 v227, v86, v87
  v_exp_f32 v88, v88
  v_exp_f32 v89, v89
  v_exp_f32 v90, v90
  v_exp_f32 v91, v91
  v_exp_f32 v92, v92
  v_exp_f32 v93, v93
  v_exp_f32 v94, v94
  v_exp_f32 v95, v95
  v_cvt_pk_bf16_f32 v228, v88, v89
  v_cvt_pk_bf16_f32 v229, v90, v91
  v_cvt_pk_bf16_f32 v230, v92, v93
  v_cvt_pk_bf16_f32 v231, v94, v95
  s_waitcnt lgkmcnt(2)
  v_mfma_f32_32x32x16_bf16 v[160:175], v[56:59], v[224:227], v[160:175]
  v_mfma_f32_32x32x16_bf16 v[160:175], v[60:63], v[228:231], v[160:175]
  s_cmp_lg_u32 s46, 7
  s_cbranch_scc1 L_m7
  v_mov_b32 v128, 0xf149f2ca
  v_mov_b32 v204, 0xf149f2ca
  v_mov_b32 v129, 0xf149f2ca
  v_mov_b32 v205, 0xf149f2ca
  v_mov_b32 v130, 0xf149f2ca
  v_mov_b32 v206, 0xf149f2ca
  v_mov_b32 v131, 0xf149f2ca
  v_mov_b32 v207, 0xf149f2ca
  v_mov_b32 v132, 0xf149f2ca
  v_mov_b32 v208, 0xf149f2ca
  v_mov_b32 v133, 0xf149f2ca
  v_mov_b32 v209, 0xf149f2ca
  v_mov_b32 v134, 0xf149f2ca
  v_mov_b32 v210, 0xf149f2ca
  v_mov_b32 v135, 0xf149f2ca
  v_mov_b32 v211, 0xf149f2ca
  v_mov_b32 v136, 0xf149f2ca
  v_mov_b32 v212, 0xf149f2ca
  v_mov_b32 v137, 0xf149f2ca
  v_mov_b32 v213, 0xf149f2ca
  v_mov_b32 v138, 0xf149f2ca
  v_mov_b32 v214, 0xf149f2ca
  v_mov_b32 v139, 0xf149f2ca
  v_mov_b32 v215, 0xf149f2ca
  v_mov_b32 v140, 0xf149f2ca
  v_mov_b32 v216, 0xf149f2ca
  v_mov_b32 v141, 0xf149f2ca
  v_mov_b32 v217, 0xf149f2ca
  v_mov_b32 v142, 0xf149f2ca
  v_mov_b32 v218, 0xf149f2ca
  v_mov_b32 v143, 0xf149f2ca
  v_mov_b32 v219, 0xf149f2ca
L_m7:
  s_nop 1
  v_mfma_f32_32x32x16_bf16 v[112:127], v[48:51], v[52:55], v[204:219]
  s_mov_b32 exec_lo, 0xffff
  s_mov_b32 exec_hi, 0xffff
  ds_read_b128 v[56:59], v9 offset:0
  ds_read_b128 v[60:63], v9 offset:512
  s_mov_b64 exec, -1
  v_exp_f32 v96, v96
  v_exp_f32 v97, v97
  v_exp_f32 v98, v98
  v_exp_f32 v99, v99
  v_exp_f32 v100, v100
  v_exp_f32 v101, v101
  v_exp_f32 v102, v102
  v_exp_f32 v103, v103
  v_cvt_pk_bf16_f32 v232, v96, v97
  v_cvt_pk_bf16_f32 v233, v98, v99
  v_cvt_pk_bf16_f32 v234, v100, v101
  v_cvt_pk_bf16_f32 v235, v102, v103
  v_exp_f32 v104, v104
  v_exp_f32 v105, v105
  v_exp_f32 v106, v106
  v_exp_f32 v107, v107
  v_exp_f32 v108, v108
  v_exp_f32 v109, v109
  v_exp_f32 v110, v110
  v_exp_f32 v111, v111
  v_cvt_pk_bf16_f32 v236, v104, v105
  v_cvt_pk_bf16_f32 v237, v106, v107
  v_cvt_pk_bf16_f32 v238, v108, v109
  v_cvt_pk_bf16_f32 v239, v110, v111
  s_waitcnt lgkmcnt(2)
  v_mfma_f32_32x32x16_bf16 v[160:175], v[64:67], v[232:235], v[160:175]
  v_mfma_f32_32x32x16_bf16 v[160:175], v[68:71], v[236:239], v[160:175]
  buffer_load_dwordx2 v[244:245], v6, s[36:39], s48 offen sc1
  v_exp_f32 v112, v112
  v_exp_f32 v113, v113
  v_exp_f32 v114, v114
  v_exp_f32 v115, v115
  v_exp_f32 v116, v116
  v_exp_f32 v117, v117
  v_exp_f32 v118, v118
  v_exp_f32 v119, v119
  v_cvt_pk_bf16_f32 v224, v112, v113
  v_cvt_pk_bf16_f32 v225, v114, v115
  v_cvt_pk_bf16_f32 v226, v116, v117
  v_cvt_pk_bf16_f32 v227, v118, v119
  v_exp_f32 v120, v120
  v_exp_f32 v121, v121
  v_exp_f32 v122, v122
  v_exp_f32 v123, v123
  v_exp_f32 v124, v124
  v_exp_f32 v125, v125
  v_exp_f32 v126, v126
  v_exp_f32 v127, v127
  v_cvt_pk_bf16_f32 v228, v120, v121
  v_cvt_pk_bf16_f32 v229, v122, v123
  v_cvt_pk_bf16_f32 v230, v124, v125
  v_cvt_pk_bf16_f32 v231, v126, v127
  s_waitcnt lgkmcnt(0)
  v_mfma_f32_32x32x16_bf16 v[160:175], v[56:59], v[224:227], v[160:175]
  v_mfma_f32_32x32x16_bf16 v[160:175], v[60:63], v[228:231], v[160:175]
  s_nop 11
  v_rcp_f32 v4, v168
  s_nop 0
  v_mul_f32 v160, v160, v4
  v_mul_f32 v161, v161, v4
  v_mul_f32 v162, v162, v4
  v_mul_f32 v163, v163, v4
  v_mul_f32 v164, v164, v4
  v_mul_f32 v165, v165, v4
  v_mul_f32 v166, v166, v4
  v_mul_f32 v167, v167, v4
  v_cvt_pk_bf16_f32 v240, v160, v161
  v_cvt_pk_bf16_f32 v241, v162, v163
  v_cvt_pk_bf16_f32 v242, v164, v165
  v_cvt_pk_bf16_f32 v243, v166, v167
  s_lshl_b32 s47, s46, 5
  s_lshl_b32 s48, s41, 1
  s_add_u32 s47, s47, s48
  s_add_u32 s47, s47, s44
  s_lshl_b32 s47, s47, 10
  s_add_u32 s47, s47, 6291456
  buffer_store_dwordx4 v[240:243], v14, s[36:39], s47 offen sc1
  s_lshl_b32 s48, s51, 1
  s_add_u32 s48, s48, s54
  s_mul_i32 s98, s48, 86
  s_add_u32 s98, s98, s57
  s_lshl_b32 s98, s98, 10
  s_add_u32 s98, s98, 8388608
  s_lshl_b32 s99, s48, 5
  s_lshl_b32 s50, s53, 3
  s_add_u32 s99, s99, s50
  s_lshl_b32 s99, s99, 10
  s_add_u32 s99, s99, 6291456
  v_and_b32 v3, 31, v1
  v_lshrrev_b32 v10, 5, v1
  v_lshlrev_b32 v10, 4, v10
  v_lshl_add_u32 v9, v3, 10, v10
  s_lshl_b32 s47, s54, 15
  s_lshl_b32 s50, s53, 5
  s_add_u32 s47, s47, s50
  v_add_u32 v9, s47, v9
  v_lshrrev_b32 v10, 5, v1
  v_bfe_u32 v3, v1, 2, 2
  v_lshl_add_u32 v3, v10, 2, v3
  v_lshlrev_b32 v3, 6, v3
  v_and_b32 v11, 16, v1
  v_lshl_add_u32 v3, v11, 1, v3
  v_and_b32 v11, 3, v1
  v_lshl_add_u32 v3, v11, 3, v3
  s_lshl_b32 s47, s53, 11
  v_add_u32 v11, s47, v3
  v_add_u32 v12, 49152, v11
  v_add_u32 v13, 98304, v11
  s_waitcnt vmcnt(1)
  v_cmp_ne_u64 vcc, s[6:7], v[244:245]
  s_nop 3
  s_cbranch_vccz L_q2
  s_mov_b32 s58, 0
  s_mov_b32 s50, 14686208
L_p2:
  buffer_load_dwordx2 v[244:245], v6, s[36:39], s50 offen offset:0 sc1
  s_waitcnt vmcnt(0)
  v_cmp_ne_u64 vcc, s[6:7], v[244:245]
  s_nop 3
  s_cbranch_vccnz L_r2
  s_branch L_q2
L_r2:
  s_sleep 1
  s_add_u32 s58, s58, 1
  s_cmp_lt_u32 s58, 0x40000
  s_cbranch_scc1 L_p2
L_q2:
  buffer_load_dwordx4 v[16:19], v14, s[36:39], s98 offen offset:0 sc1
  buffer_load_dwordx4 v[20:23], v14, s[36:39], s98 offen offset:1024 sc1
  buffer_load_dwordx4 v[24:27], v14, s[36:39], s98 offen offset:2048 sc1
  buffer_load_dwordx4 v[28:31], v14, s[36:39], s98 offen offset:3072 sc1
  s_add_u32 s98, s98, 4096
  buffer_load_dwordx4 v[32:35], v14, s[36:39], s98 offen offset:0 sc1
  buffer_load_dwordx4 v[36:39], v14, s[36:39], s98 offen offset:1024 sc1
  s_barrier
  ds_read_b64_tr_b16 v[208:209], v13 offset:0
  ds_read_b64_tr_b16 v[210:211], v13 offset:512
  ds_read_b64_tr_b16 v[212:213], v13 offset:1024
  ds_read_b64_tr_b16 v[214:215], v13 offset:1536
  ds_read_b64_tr_b16 v[216:217], v13 offset:8192
  ds_read_b64_tr_b16 v[218:219], v13 offset:8704
  ds_read_b64_tr_b16 v[220:221], v13 offset:9216
  ds_read_b64_tr_b16 v[222:223], v13 offset:9728
  ds_read_b64_tr_b16 v[224:225], v13 offset:16384
  ds_read_b64_tr_b16 v[226:227], v13 offset:16896
  ds_read_b64_tr_b16 v[228:229], v13 offset:17408
  ds_read_b64_tr_b16 v[230:231], v13 offset:17920
  buffer_load_dwordx4 v[40:43], v14, s[36:39], s98 offen offset:2048 sc1
  s_waitcnt vmcnt(6) lgkmcnt(8)
  v_mfma_f32_32x32x16_bf16 v[136:151], v[208:211], v[16:19], 0
  v_mfma_f32_32x32x16_bf16 v[152:167], v[212:215], v[16:19], 0
  v_mov_b32 v3, 160772
  v_mov_b32 v10, 1
  s_mov_b64 exec, 1
  ds_add_rtn_u32 v10, v3, v10
  s_waitcnt lgkmcnt(0)
  s_mov_b64 exec, -1
  v_readfirstlane_b32 s47, v10
  s_nop 1
  s_cmp_lg_u32 s47, 7
  s_cbranch_scc1 L_f3
  s_mov_b64 exec, 1
  s_lshl_b32 s47, s55, 3
  s_add_u32 s47, s47, 14688256
  v_mov_b32 v4, s6
  v_mov_b32 v5, s7
  v_mov_b32 v3, 0
  buffer_store_dwordx2 v[4:5], v3, s[36:39], s47 offen sc1
  s_mov_b64 exec, -1
L_f3:
  ds_read_b64_tr_b16 v[208:209], v13 offset:24576
  ds_read_b64_tr_b16 v[210:211], v13 offset:25088
  ds_read_b64_tr_b16 v[212:213], v13 offset:25600
  ds_read_b64_tr_b16 v[214:215], v13 offset:26112
  s_add_u32 m0, s56, 49152
  s_nop 0
  buffer_load_dwordx4 v8, s[24:27], s49 offen offset:0 lds
  s_add_u32 m0, s56, 50112
  s_nop 0
  buffer_load_dwordx4 v8, s[24:27], s49 offen offset:64 lds
  s_add_u32 s49, s49, 32768
  buffer_load_dwordx4 v[44:47], v14, s[36:39], s98 offen offset:3072 sc1
  s_add_u32 s98, s98, 4096
  s_waitcnt vmcnt(8) lgkmcnt(8)
  v_mfma_f32_32x32x16_bf16 v[136:151], v[216:219], v[20:23], v[136:151]
  v_mfma_f32_32x32x16_bf16 v[152:167], v[220:223], v[20:23], v[152:167]
  ds_read_b64_tr_b16 v[216:217], v13 offset:32768
  ds_read_b64_tr_b16 v[218:219], v13 offset:33280
  ds_read_b64_tr_b16 v[220:221], v13 offset:33792
  ds_read_b64_tr_b16 v[222:223], v13 offset:34304
  buffer_load_dwordx4 v[48:51], v14, s[36:39], s98 offen offset:0 sc1
  s_waitcnt vmcnt(8) lgkmcnt(8)
  v_mfma_f32_32x32x16_bf16 v[136:151], v[224:227], v[24:27], v[136:151]
  v_mfma_f32_32x32x16_bf16 v[152:167], v[228:231], v[24:27], v[152:167]
  s_or_b32 s47, s55, s42
  s_cmp_lg_u32 s47, 0
  s_cbranch_scc1 L_noep
  v_lshlrev_b32 v7, 3, v1
  s_mov_b32 s58, 0
  s_mov_b32 s50, 14684160
L_pe:
  buffer_load_dwordx2 v[244:245], v7, s[36:39], s50 offen offset:0 sc1
  buffer_load_dwordx2 v[246:247], v7, s[36:39], s50 offen offset:512 sc1
  buffer_load_dwordx2 v[248:249], v7, s[36:39], s50 offen offset:1024 sc1
  buffer_load_dwordx2 v[250:251], v7, s[36:39], s50 offen offset:1536 sc1
  s_waitcnt vmcnt(0)
  v_cmp_ne_u64 vcc, s[6:7], v[244:245]
  s_nop 3
  s_cbranch_vccnz L_re
  v_cmp_ne_u64 vcc, s[6:7], v[246:247]
  s_nop 3
  s_cbranch_vccnz L_re
  v_cmp_ne_u64 vcc, s[6:7], v[248:249]
  s_nop 3
  s_cbranch_vccnz L_re
  v_cmp_ne_u64 vcc, s[6:7], v[250:251]
  s_nop 3
  s_cbranch_vccnz L_re
  s_branch L_qe
L_re:
  s_sleep 1
  s_add_u32 s58, s58, 1
  s_cmp_lt_u32 s58, 0x40000
  s_cbranch_scc1 L_pe
L_qe:
  v_mov_b32 v4, s6
  v_mov_b32 v5, s7
  v_mov_b32 v3, 0
  s_mov_b32 s47, 14680064
  s_mov_b64 exec, 1
  buffer_store_dwordx2 v[4:5], v3, s[36:39], s47 offen sc1
  s_mov_b64 exec, -1
L_noep:
  ds_read_b64_tr_b16 v[224:225], v13 offset:40960
  ds_read_b64_tr_b16 v[226:227], v13 offset:41472
  ds_read_b64_tr_b16 v[228:229], v13 offset:41984
  ds_read_b64_tr_b16 v[230:231], v13 offset:42496
  s_add_u32 m0, s56, 65536
  s_nop 0
  buffer_load_dwordx4 v8, s[24:27], s49 offen offset:0 lds
  s_add_u32 m0, s56, 66496
  s_nop 0
  buffer_load_dwordx4 v8, s[24:27], s49 offen offset:64 lds
  s_add_u32 s49, s49, 32768
  buffer_load_dwordx4 v[52:55], v14, s[36:39], s98 offen offset:1024 sc1
  s_waitcnt vmcnt(10) lgkmcnt(8)
  v_mfma_f32_32x32x16_bf16 v[136:151], v[208:211], v[28:31], v[136:151]
  v_mfma_f32_32x32x16_bf16 v[152:167], v[212:215], v[28:31], v[152:167]
  ds_read_b64_tr_b16 v[208:209], v11 offset:0
  ds_read_b64_tr_b16 v[210:211], v11 offset:512
  ds_read_b64_tr_b16 v[212:213], v11 offset:1024
  ds_read_b64_tr_b16 v[214:215], v11 offset:1536
  buffer_load_dwordx4 v[56:59], v14, s[36:39], s98 offen offset:2048 sc1
  s_waitcnt vmcnt(10) lgkmcnt(8)
  v_mfma_f32_32x32x16_bf16 v[136:151], v[216:219], v[32:35], v[136:151]
  v_mfma_f32_32x32x16_bf16 v[152:167], v[220:223], v[32:35], v[152:167]
  ds_read_b64_tr_b16 v[216:217], v11 offset:8192
  ds_read_b64_tr_b16 v[218:219], v11 offset:8704
  ds_read_b64_tr_b16 v[220:221], v11 offset:9216
  ds_read_b64_tr_b16 v[222:223], v11 offset:9728
  s_add_u32 m0, s56, 81920
  s_nop 0
  buffer_load_dwordx4 v8, s[24:27], s49 offen offset:0 lds
  s_add_u32 m0, s56, 82880
  s_nop 0
  buffer_load_dwordx4 v8, s[24:27], s49 offen offset:64 lds
  s_add_u32 s49, s49, 32768
  buffer_load_dwordx4 v[60:63], v14, s[36:39], s98 offen offset:3072 sc1
  s_add_u32 s98, s98, 4096
  s_waitcnt vmcnt(12) lgkmcnt(8)
  v_mfma_f32_32x32x16_bf16 v[136:151], v[224:227], v[36:39], v[136:151]
  v_mfma_f32_32x32x16_bf16 v[152:167], v[228:231], v[36:39], v[152:167]
  s_barrier
  ds_read_b64_tr_b16 v[224:225], v11 offset:16384
  ds_read_b64_tr_b16 v[226:227], v11 offset:16896
  ds_read_b64_tr_b16 v[228:229], v11 offset:17408
  ds_read_b64_tr_b16 v[230:231], v11 offset:17920
  s_add_u32 m0, s56, 98304
  s_nop 0
  buffer_load_dwordx4 v8, s[24:27], s49 offen offset:0 lds
  s_add_u32 m0, s56, 99264
  s_nop 0
  buffer_load_dwordx4 v8, s[24:27], s49 offen offset:64 lds
  s_add_u32 s49, s49, 32768
  buffer_load_dwordx4 v[64:67], v14, s[36:39], s98 offen offset:0 sc1
  s_waitcnt vmcnt(14) lgkmcnt(8)
  v_mfma_f32_32x32x16_bf16 v[136:151], v[208:211], v[40:43], v[136:151]
  v_mfma_f32_32x32x16_bf16 v[152:167], v[212:215], v[40:43], v[152:167]
  ds_read_b64_tr_b16 v[208:209], v11 offset:24576
  ds_read_b64_tr_b16 v[210:211], v11 offset:25088
  ds_read_b64_tr_b16 v[212:213], v11 offset:25600
  ds_read_b64_tr_b16 v[214:215], v11 offset:26112
  buffer_load_dwordx4 v[68:71], v14, s[36:39], s98 offen offset:1024 sc1
  s_waitcnt vmcnt(12) lgkmcnt(8)
  v_mfma_f32_32x32x16_bf16 v[136:151], v[216:219], v[44:47], v[136:151]
  v_mfma_f32_32x32x16_bf16 v[152:167], v[220:223], v[44:47], v[152:167]
  ds_read_b64_tr_b16 v[216:217], v11 offset:32768
  ds_read_b64_tr_b16 v[218:219], v11 offset:33280
  ds_read_b64_tr_b16 v[220:221], v11 offset:33792
  ds_read_b64_tr_b16 v[222:223], v11 offset:34304
  s_add_u32 m0, s56, 114688
  s_nop 0
  buffer_load_dwordx4 v8, s[24:27], s49 offen offset:0 lds
  s_add_u32 m0, s56, 115648
  s_nop 0
  buffer_load_dwordx4 v8, s[24:27], s49 offen offset:64 lds
  s_add_u32 s49, s49, 32768
  buffer_load_dwordx4 v[72:75], v14, s[36:39], s98 offen offset:2048 sc1
  s_waitcnt vmcnt(14) lgkmcnt(8)
  v_mfma_f32_32x32x16_bf16 v[136:151], v[224:227], v[48:51], v[136:151]
  v_mfma_f32_32x32x16_bf16 v[152:167], v[228:231], v[48:51], v[152:167]
  ds_read_b64_tr_b16 v[224:225], v11 offset:40960
  ds_read_b64_tr_b16 v[226:227], v11 offset:41472
  ds_read_b64_tr_b16 v[228:229], v11 offset:41984
  ds_read_b64_tr_b16 v[230:231], v11 offset:42496
  buffer_load_dwordx4 v[76:79], v14, s[36:39], s98 offen offset:3072 sc1
  s_add_u32 s98, s98, 4096
  s_waitcnt vmcnt(12) lgkmcnt(8)
  v_mfma_f32_32x32x16_bf16 v[136:151], v[208:211], v[52:55], v[136:151]
  v_mfma_f32_32x32x16_bf16 v[152:167], v[212:215], v[52:55], v[152:167]
  s_waitcnt vmcnt(9)
  s_barrier
  ds_read_b64_tr_b16 v[208:209], v12 offset:0
  ds_read_b64_tr_b16 v[210:211], v12 offset:512
  ds_read_b64_tr_b16 v[212:213], v12 offset:1024
  ds_read_b64_tr_b16 v[214:215], v12 offset:1536
  s_lshl_b32 s49, s53, 3
  s_add_u32 s49, s49, s54
  s_lshl_b32 s49, s49, 14
  s_lshl_b32 s47, s52, 7
  s_add_u32 s49, s49, s47
  s_add_u32 m0, s56, 131072
  s_nop 0
  buffer_load_dwordx4 v8, s[16:19], s49 offen offset:0 lds
  s_add_u32 m0, s56, 132032
  s_nop 0
  buffer_load_dwordx4 v8, s[16:19], s49 offen offset:64 lds
  s_add_u32 s49, s49, 32768
  buffer_load_dwordx4 v[80:83], v14, s[36:39], s98 offen offset:0 sc1
  s_waitcnt lgkmcnt(8)
  v_mfma_f32_32x32x16_bf16 v[136:151], v[216:219], v[56:59], v[136:151]
  v_mfma_f32_32x32x16_bf16 v[152:167], v[220:223], v[56:59], v[152:167]
  ds_read_b64_tr_b16 v[216:217], v12 offset:8192
  ds_read_b64_tr_b16 v[218:219], v12 offset:8704
  ds_read_b64_tr_b16 v[220:221], v12 offset:9216
  ds_read_b64_tr_b16 v[222:223], v12 offset:9728
  buffer_load_dwordx4 v[84:87], v14, s[36:39], s98 offen offset:1024 sc1
  s_waitcnt vmcnt(12) lgkmcnt(8)
  v_mfma_f32_32x32x16_bf16 v[136:151], v[224:227], v[60:63], v[136:151]
  v_mfma_f32_32x32x16_bf16 v[152:167], v[228:231], v[60:63], v[152:167]
  ds_read_b64_tr_b16 v[224:225], v12 offset:16384
  ds_read_b64_tr_b16 v[226:227], v12 offset:16896
  ds_read_b64_tr_b16 v[228:229], v12 offset:17408
  ds_read_b64_tr_b16 v[230:231], v12 offset:17920
  buffer_load_dwordx4 v[88:91], v14, s[36:39], s98 offen offset:2048 sc1
  s_waitcnt vmcnt(10) lgkmcnt(8)
  v_mfma_f32_32x32x16_bf16 v[136:151], v[208:211], v[64:67], v[136:151]
  v_mfma_f32_32x32x16_bf16 v[152:167], v[212:215], v[64:67], v[152:167]
  ds_read_b64_tr_b16 v[208:209], v12 offset:24576
  ds_read_b64_tr_b16 v[210:211], v12 offset:25088
  ds_read_b64_tr_b16 v[212:213], v12 offset:25600
  ds_read_b64_tr_b16 v[214:215], v12 offset:26112
  buffer_load_dwordx4 v[92:95], v14, s[36:39], s98 offen offset:3072 sc1
  s_add_u32 s98, s98, 4096
  s_waitcnt vmcnt(10) lgkmcnt(8)
  v_mfma_f32_32x32x16_bf16 v[136:151], v[216:219], v[68:71], v[136:151]
  v_mfma_f32_32x32x16_bf16 v[152:167], v[220:223], v[68:71], v[152:167]
  ds_read_b64_tr_b16 v[216:217], v12 offset:32768
  ds_read_b64_tr_b16 v[218:219], v12 offset:33280
  ds_read_b64_tr_b16 v[220:221], v12 offset:33792
  ds_read_b64_tr_b16 v[222:223], v12 offset:34304
  buffer_load_dwordx4 v[96:99], v14, s[36:39], s98 offen offset:0 sc1
  s_waitcnt vmcnt(8) lgkmcnt(8)
  v_mfma_f32_32x32x16_bf16 v[136:151], v[224:227], v[72:75], v[136:151]
  v_mfma_f32_32x32x16_bf16 v[152:167], v[228:231], v[72:75], v[152:167]
  ds_read_b64_tr_b16 v[224:225], v12 offset:40960
  ds_read_b64_tr_b16 v[226:227], v12 offset:41472
  ds_read_b64_tr_b16 v[228:229], v12 offset:41984
  ds_read_b64_tr_b16 v[230:231], v12 offset:42496
  buffer_load_dwordx4 v[100:103], v14, s[36:39], s98 offen offset:1024 sc1
  s_waitcnt vmcnt(8) lgkmcnt(8)
  v_mfma_f32_32x32x16_bf16 v[136:151], v[208:211], v[76:79], v[136:151]
  v_mfma_f32_32x32x16_bf16 v[152:167], v[212:215], v[76:79], v[152:167]
  s_waitcnt vmcnt(6)
  s_barrier
  ds_read_b64_tr_b16 v[208:209], v13 offset:0
  ds_read_b64_tr_b16 v[210:211], v13 offset:512
  ds_read_b64_tr_b16 v[212:213], v13 offset:1024
  ds_read_b64_tr_b16 v[214:215], v13 offset:1536
  s_add_u32 m0, s56, 0
  s_nop 0
  buffer_load_dwordx4 v8, s[16:19], s49 offen offset:0 lds
  s_add_u32 m0, s56, 960
  s_nop 0
  buffer_load_dwordx4 v8, s[16:19], s49 offen offset:64 lds
  s_add_u32 s49, s49, 32768
  s_waitcnt vmcnt(7) lgkmcnt(8)
  v_mfma_f32_32x32x16_bf16 v[136:151], v[216:219], v[80:83], v[136:151]
  v_mfma_f32_32x32x16_bf16 v[152:167], v[220:223], v[80:83], v[152:167]
  s_mov_b32 s48, 14688256
  buffer_load_dwordx2 v[244:245], v6, s[36:39], s48 offen sc1
  ds_read_b64_tr_b16 v[216:217], v13 offset:8192
  ds_read_b64_tr_b16 v[218:219], v13 offset:8704
  ds_read_b64_tr_b16 v[220:221], v13 offset:9216
  ds_read_b64_tr_b16 v[222:223], v13 offset:9728
  s_add_u32 m0, s56, 16384
  s_nop 0
  buffer_load_dwordx4 v8, s[16:19], s49 offen offset:0 lds
  s_add_u32 m0, s56, 17344
  s_nop 0
  buffer_load_dwordx4 v8, s[16:19], s49 offen offset:64 lds
  s_add_u32 s49, s49, 32768
  s_waitcnt vmcnt(9) lgkmcnt(8)
  v_mfma_f32_32x32x16_bf16 v[136:151], v[224:227], v[84:87], v[136:151]
  v_mfma_f32_32x32x16_bf16 v[152:167], v[228:231], v[84:87], v[152:167]
  ds_read_b64_tr_b16 v[224:225], v13 offset:16384
  ds_read_b64_tr_b16 v[226:227], v13 offset:16896
  ds_read_b64_tr_b16 v[228:229], v13 offset:17408
  ds_read_b64_tr_b16 v[230:231], v13 offset:17920
  s_add_u32 m0, s56, 32768
  s_nop 0
  buffer_load_dwordx4 v8, s[16:19], s49 offen offset:0 lds
  s_add_u32 m0, s56, 33728
  s_nop 0
  buffer_load_dwordx4 v8, s[16:19], s49 offen offset:64 lds
  s_add_u32 s49, s49, 32768
  s_waitcnt vmcnt(10) lgkmcnt(8)
  v_mfma_f32_32x32x16_bf16 v[136:151], v[208:211], v[88:91], v[136:151]
  v_mfma_f32_32x32x16_bf16 v[152:167], v[212:215], v[88:91], v[152:167]
  s_waitcnt vmcnt(4)
  v_cmp_ne_u64 vcc, s[6:7], v[244:245]
  s_nop 3
  s_cbranch_vccz L_q3
  s_mov_b32 s58, 0
  s_mov_b32 s50, 14688256
L_p3:
  buffer_load_dwordx2 v[244:245], v6, s[36:39], s50 offen offset:0 sc1
  s_waitcnt vmcnt(0)
  v_cmp_ne_u64 vcc, s[6:7], v[244:245]
  s_nop 3
  s_cbranch_vccnz L_r3
  s_branch L_q3
L_r3:
  s_sleep 1
  s_add_u32 s58, s58, 1
  s_cmp_lt_u32 s58, 0x40000
  s_cbranch_scc1 L_p3
L_q3:
  ds_read_b64_tr_b16 v[208:209], v13 offset:24576
  ds_read_b64_tr_b16 v[210:211], v13 offset:25088
  ds_read_b64_tr_b16 v[212:213], v13 offset:25600
  ds_read_b64_tr_b16 v[214:215], v13 offset:26112
  buffer_load_dwordx4 v[104:107], v14, s[36:39], s99 offen offset:0 sc1
  buffer_load_dwordx4 v[108:111], v14, s[36:39], s99 offen offset:1024 sc1
  s_waitcnt lgkmcnt(8)
  v_mfma_f32_32x32x16_bf16 v[136:151], v[216:219], v[92:95], v[136:151]
  v_mfma_f32_32x32x16_bf16 v[152:167], v[220:223], v[92:95], v[152:167]
  ds_read_b64_tr_b16 v[216:217], v13 offset:32768
  ds_read_b64_tr_b16 v[218:219], v13 offset:33280
  ds_read_b64_tr_b16 v[220:221], v13 offset:33792
  ds_read_b64_tr_b16 v[222:223], v13 offset:34304
  buffer_load_dwordx4 v[112:115], v14, s[36:39], s99 offen offset:2048 sc1
  buffer_load_dwordx4 v[116:119], v14, s[36:39], s99 offen offset:3072 sc1
  s_add_u32 s99, s99, 4096
  s_lshl_b32 s50, s51, 16
  s_lshl_b32 s47, s52, 7
  s_add_u32 s50, s50, s47
  buffer_load_dwordx4 v[204:207], v9, s[8:11], s50 offen
  s_waitcnt lgkmcnt(8)
  v_mfma_f32_32x32x16_bf16 v[136:151], v[224:227], v[96:99], v[136:151]
  v_mfma_f32_32x32x16_bf16 v[152:167], v[228:231], v[96:99], v[152:167]
  ds_read_b64_tr_b16 v[224:225], v13 offset:40960
  ds_read_b64_tr_b16 v[226:227], v13 offset:41472
  ds_read_b64_tr_b16 v[228:229], v13 offset:41984
  ds_read_b64_tr_b16 v[230:231], v13 offset:42496
  buffer_load_dwordx4 v[120:123], v14, s[36:39], s99 offen offset:0 sc1
  buffer_load_dwordx4 v[124:127], v14, s[36:39], s99 offen offset:1024 sc1
  s_waitcnt lgkmcnt(8)
  s_cmp_ge_u32 s53, 2
  s_cbranch_scc1 L_s21
  v_mfma_f32_32x32x16_bf16 v[136:151], v[208:211], v[100:103], v[136:151]
  v_mfma_f32_32x32x16_bf16 v[152:167], v[212:215], v[100:103], v[152:167]
L_s21:
  s_waitcnt vmcnt(7)
  s_barrier
  ds_read_b64_tr_b16 v[208:209], v11 offset:0
  ds_read_b64_tr_b16 v[210:211], v11 offset:512
  ds_read_b64_tr_b16 v[212:213], v11 offset:1024
  ds_read_b64_tr_b16 v[214:215], v11 offset:1536
  buffer_load_dwordx4 v[128:131], v14, s[36:39], s99 offen offset:2048 sc1
  buffer_load_dwordx4 v[132:135], v14, s[36:39], s99 offen offset:3072 sc1
  s_add_u32 s99, s99, 4096
  s_waitcnt vmcnt(8) lgkmcnt(8)
  v_mfma_f32_32x32x16_bf16 v[136:151], v[216:219], v[104:107], v[136:151]
  v_mfma_f32_32x32x16_bf16 v[152:167], v[220:223], v[104:107], v[152:167]
  ds_read_b64_tr_b16 v[216:217], v11 offset:8192
  ds_read_b64_tr_b16 v[218:219], v11 offset:8704
  ds_read_b64_tr_b16 v[220:221], v11 offset:9216
  ds_read_b64_tr_b16 v[222:223], v11 offset:9728
  s_waitcnt vmcnt(7) lgkmcnt(8)
  v_mfma_f32_32x32x16_bf16 v[136:151], v[224:227], v[108:111], v[136:151]
  v_mfma_f32_32x32x16_bf16 v[152:167], v[228:231], v[108:111], v[152:167]
  ds_read_b64_tr_b16 v[224:225], v11 offset:16384
  ds_read_b64_tr_b16 v[226:227], v11 offset:16896
  ds_read_b64_tr_b16 v[228:229], v11 offset:17408
  ds_read_b64_tr_b16 v[230:231], v11 offset:17920
  s_waitcnt vmcnt(6) lgkmcnt(8)
  v_mfma_f32_32x32x16_bf16 v[136:151], v[208:211], v[112:115], v[136:151]
  v_mfma_f32_32x32x16_bf16 v[152:167], v[212:215], v[112:115], v[152:167]
  ds_read_b64_tr_b16 v[208:209], v11 offset:24576
  ds_read_b64_tr_b16 v[210:211], v11 offset:25088
  ds_read_b64_tr_b16 v[212:213], v11 offset:25600
  ds_read_b64_tr_b16 v[214:215], v11 offset:26112
  s_waitcnt vmcnt(5) lgkmcnt(8)
  v_mfma_f32_32x32x16_bf16 v[136:151], v[216:219], v[116:119], v[136:151]
  v_mfma_f32_32x32x16_bf16 v[152:167], v[220:223], v[116:119], v[152:167]
  s_barrier
  ds_read_b64_tr_b16 v[216:217], v11 offset:32768
  ds_read_b64_tr_b16 v[218:219], v11 offset:33280
  ds_read_b64_tr_b16 v[220:221], v11 offset:33792
  ds_read_b64_tr_b16 v[222:223], v11 offset:34304
  s_waitcnt vmcnt(3) lgkmcnt(8)
  v_mfma_f32_32x32x16_bf16 v[136:151], v[224:227], v[120:123], v[136:151]
  v_mfma_f32_32x32x16_bf16 v[152:167], v[228:231], v[120:123], v[152:167]
  ds_read_b64_tr_b16 v[224:225], v11 offset:40960
  ds_read_b64_tr_b16 v[226:227], v11 offset:41472
  ds_read_b64_tr_b16 v[228:229], v11 offset:41984
  ds_read_b64_tr_b16 v[230:231], v11 offset:42496
  s_waitcnt vmcnt(2) lgkmcnt(8)
  v_mfma_f32_32x32x16_bf16 v[136:151], v[208:211], v[124:127], v[136:151]
  v_mfma_f32_32x32x16_bf16 v[152:167], v[212:215], v[124:127], v[152:167]
  s_waitcnt vmcnt(1) lgkmcnt(4)
  v_mfma_f32_32x32x16_bf16 v[136:151], v[216:219], v[128:131], v[136:151]
  v_mfma_f32_32x32x16_bf16 v[152:167], v[220:223], v[128:131], v[152:167]
  v_permlane32_swap_b32 v204, v206
  v_permlane32_swap_b32 v205, v207
  s_waitcnt vmcnt(0) lgkmcnt(0)
  v_mfma_f32_32x32x16_bf16 v[136:151], v[224:227], v[132:135], v[136:151]
  v_mfma_f32_32x32x16_bf16 v[152:167], v[228:231], v[132:135], v[152:167]
  s_lshl_b32 s47, s42, 11
  s_add_u32 s47, s47, 98304
  v_add_u32 v3, s47, v14
  s_nop 15
  s_cmp_eq_u32 s53, 0
  s_cbranch_scc1 L_o0
  ds_write_b128 v3, v[136:139] offset:0
  ds_write_b128 v3, v[140:143] offset:1024
  s_branch L_n0
L_o0:
  v_lshlrev_b32 v64, 16, v204
  v_and_b32 v65, 0xffff0000, v204
  v_pk_add_f32 v[64:65], v[64:65], v[136:137]
  v_lshlrev_b32 v66, 16, v205
  v_and_b32 v67, 0xffff0000, v205
  v_pk_add_f32 v[66:67], v[66:67], v[138:139]
  v_lshlrev_b32 v68, 16, v206
  v_and_b32 v69, 0xffff0000, v206
  v_pk_add_f32 v[68:69], v[68:69], v[140:141]
  v_lshlrev_b32 v70, 16, v207
  v_and_b32 v71, 0xffff0000, v207
  v_pk_add_f32 v[70:71], v[70:71], v[142:143]
L_n0:
  s_cmp_eq_u32 s53, 1
  s_cbranch_scc1 L_o1
  ds_write_b128 v3, v[144:147] offset:16384
  ds_write_b128 v3, v[148:151] offset:17408
  s_branch L_n1
L_o1:
  v_lshlrev_b32 v64, 16, v204
  v_and_b32 v65, 0xffff0000, v204
  v_pk_add_f32 v[64:65], v[64:65], v[144:145]
  v_lshlrev_b32 v66, 16, v205
  v_and_b32 v67, 0xffff0000, v205
  v_pk_add_f32 v[66:67], v[66:67], v[146:147]
  v_lshlrev_b32 v68, 16, v206
  v_and_b32 v69, 0xffff0000, v206
  v_pk_add_f32 v[68:69], v[68:69], v[148:149]
  v_lshlrev_b32 v70, 16, v207
  v_and_b32 v71, 0xffff0000, v207
  v_pk_add_f32 v[70:71], v[70:71], v[150:151]
L_n1:
  s_cmp_eq_u32 s53, 2
  s_cbranch_scc1 L_o2
  ds_write_b128 v3, v[152:155] offset:32768
  ds_write_b128 v3, v[156:159] offset:33792
  s_branch L_n2
L_o2:
  v_lshlrev_b32 v64, 16, v204
  v_and_b32 v65, 0xffff0000, v204
  v_pk_add_f32 v[64:65], v[64:65], v[152:153]
  v_lshlrev_b32 v66, 16, v205
  v_and_b32 v67, 0xffff0000, v205
  v_pk_add_f32 v[66:67], v[66:67], v[154:155]
  v_lshlrev_b32 v68, 16, v206
  v_and_b32 v69, 0xffff0000, v206
  v_pk_add_f32 v[68:69], v[68:69], v[156:157]
  v_lshlrev_b32 v70, 16, v207
  v_and_b32 v71, 0xffff0000, v207
  v_pk_add_f32 v[70:71], v[70:71], v[158:159]
L_n2:
  s_cmp_eq_u32 s53, 3
  s_cbranch_scc1 L_o3
  ds_write_b128 v3, v[160:163] offset:49152
  ds_write_b128 v3, v[164:167] offset:50176
  s_branch L_n3
L_o3:
  v_lshlrev_b32 v64, 16, v204
  v_and_b32 v65, 0xffff0000, v204
  v_pk_add_f32 v[64:65], v[64:65], v[160:161]
  v_lshlrev_b32 v66, 16, v205
  v_and_b32 v67, 0xffff0000, v205
  v_pk_add_f32 v[66:67], v[66:67], v[162:163]
  v_lshlrev_b32 v68, 16, v206
  v_and_b32 v69, 0xffff0000, v206
  v_pk_add_f32 v[68:69], v[68:69], v[164:165]
  v_lshlrev_b32 v70, 16, v207
  v_and_b32 v71, 0xffff0000, v207
  v_pk_add_f32 v[70:71], v[70:71], v[166:167]
L_n3:
  s_lshl_b32 s47, s53, 14
  s_add_u32 s47, s47, 98304
  s_add_u32 s48, s42, 2
  s_and_b32 s48, s48, 7
  s_lshl_b32 s48, s48, 11
  s_add_u32 s48, s48, s47
  v_add_u32 v4, s48, v14
  s_add_u32 s48, s42, 4
  s_and_b32 s48, s48, 7
  s_lshl_b32 s48, s48, 11
  s_add_u32 s48, s48, s47
  v_add_u32 v5, s48, v14
  s_add_u32 s48, s42, 6
  s_and_b32 s48, s48, 7
  s_lshl_b32 s48, s48, 11
  s_add_u32 s48, s48, s47
  v_add_u32 v6, s48, v14
  s_waitcnt lgkmcnt(0)
  s_barrier
  ds_read_b128 v[24:27], v4 offset:0
  ds_read_b128 v[28:31], v4 offset:1024
  ds_read_b128 v[32:35], v5 offset:0
  ds_read_b128 v[36:39], v5 offset:1024
  ds_read_b128 v[40:43], v6 offset:0
  ds_read_b128 v[44:47], v6 offset:1024
  s_waitcnt lgkmcnt(4)
  v_pk_add_f32 v[64:65], v[64:65], v[24:25]
  v_pk_add_f32 v[66:67], v[66:67], v[26:27]
  v_pk_add_f32 v[68:69], v[68:69], v[28:29]
  v_pk_add_f32 v[70:71], v[70:71], v[30:31]
  s_waitcnt lgkmcnt(2)
  v_pk_add_f32 v[64:65], v[64:65], v[32:33]
  v_pk_add_f32 v[66:67], v[66:67], v[34:35]
  v_pk_add_f32 v[68:69], v[68:69], v[36:37]
  v_pk_add_f32 v[70:71], v[70:71], v[38:39]
  s_waitcnt lgkmcnt(0)
  v_pk_add_f32 v[64:65], v[64:65], v[40:41]
  v_pk_add_f32 v[66:67], v[66:67], v[42:43]
  v_pk_add_f32 v[68:69], v[68:69], v[44:45]
  v_pk_add_f32 v[70:71], v[70:71], v[46:47]
  v_cvt_pk_bf16_f32 v72, v64, v65
  v_cvt_pk_bf16_f32 v73, v66, v67
  v_cvt_pk_bf16_f32 v74, v68, v69
  v_cvt_pk_bf16_f32 v75, v70, v71
  s_nop 0
  v_permlane32_swap_b32 v72, v74
  v_permlane32_swap_b32 v73, v75
  s_lshl_b32 s50, s51, 16
  s_lshl_b32 s47, s52, 7
  s_add_u32 s50, s50, s47
  buffer_store_dwordx4 v[72:75], v9, s[28:31], s50 offen
L_end:
  s_endpgm
.section .rodata,"a"
.p2align 6
.amdhsa_kernel parallel_sum__sliding_block__dense_activation_silu__prompt_kernel
  .amdhsa_next_free_vgpr 256
  .amdhsa_next_free_sgpr 102
  .amdhsa_accum_offset 256
  .amdhsa_group_segment_fixed_size 0
  .amdhsa_kernarg_size 72
  .amdhsa_user_sgpr_count 2
  .amdhsa_user_sgpr_kernarg_segment_ptr 1
  .amdhsa_system_sgpr_workgroup_id_x 1
.end_amdhsa_kernel
```
